```python
import torch

def _softmax(x, axis=-1):
    return torch.softmax(x, dim=axis)
def _gelu(x):
    return torch.nn.functional.gelu(x, approximate="tanh")
def _silu(x):
    return torch.nn.functional.silu(x)
def _sigmoid(x):
    return torch.sigmoid(x)
def _layernorm(x, axis=-1, eps=1e-5):
    m = x.mean(dim=axis, keepdim=True)
    v = x.var(dim=axis, keepdim=True, unbiased=False)
    return (x - m) / torch.sqrt(v + eps)
def _scatter_add(tgt, idx, src, axis=0):
    return tgt.clone().index_add_(axis, idx, src)
def _segment_sum(src, seg, n):
    out = torch.zeros((n,) + src.shape[1:], dtype=src.dtype)
    return out.index_add_(0, seg, src)
def _pad(x, pw):
    flat = tuple(v for pair in reversed(pw) for v in pair)
    return torch.nn.functional.pad(x, flat)

kernel_name = 'recurrent_scan__sliding_block__dense_activation_relu__prompt'

def setup_inputs():

    _w = (lambda a: (lambda t: t.to(torch.bfloat16) if t.is_floating_point() else t)(torch.as_tensor(a)))
    def _A_setup():
        B, S, D = 1, 2048, 640
        return {
            "x": _w((lambda *s: torch.randn(*s, dtype=torch.bfloat16) * 0.05)(B, S, D)),
            "wqkv": _w((lambda *s: torch.randn(*s, dtype=torch.bfloat16) * 0.05)(D, 3 * D)),
            "wo": _w((lambda *s: torch.randn(*s, dtype=torch.bfloat16) * 0.05)(D, D)),
        }
    _A_in = _A_setup()

    def _B_setup():
        B, S, D, Dff = 1, 2048, 640, 1536
        return {
            "x": _w((lambda *s: torch.randn(*s, dtype=torch.bfloat16) * 0.05)(B, S, D)),
            "w1": _w((lambda *s: torch.randn(*s, dtype=torch.bfloat16) * 0.05)(D, Dff)),
            "w2": _w((lambda *s: torch.randn(*s, dtype=torch.bfloat16) * 0.05)(Dff, D)),
        }
    _B_in = _B_setup()

    return {
        "A_x": _A_in["x"],
        "A_wqkv": _A_in["wqkv"],
        "A_wo": _A_in["wo"],
        "B_x": _B_in["x"],
        "B_w1": _B_in["w1"],
        "B_w2": _B_in["w2"],
    }

def reference(A_x, A_wqkv, A_wo, B_x, B_w1, B_w2):
    def _A_ref(x, wqkv, wo):
        B, S, D = x.shape
        H = 32; Dh = D // H; W = 256
        qkv = (lambda x, *d: x.permute(*d))((x @ wqkv).reshape(B, S, 3, H, Dh), 2, 0, 3, 1, 4)
        q, k, v = qkv[0], qkv[1], qkv[2]
        scores = torch.einsum("bhqd,bhkd->bhqk", q, k) * (Dh ** -0.5)
        idx = torch.arange(S)
        mask = (idx[:, None] - idx[None, :] >= 0) & (idx[:, None] - idx[None, :] < W)
        scores = torch.where(mask[None, None], scores, -1e9)
        p = _softmax(scores, axis=-1)
        o = torch.einsum("bhqk,bhkd->bhqd", p, v)
        return (lambda x, *d: x.permute(*d))(o, 0, 2, 1, 3).reshape(B, S, D) @ wo

    def _B_ref(x, w1, w2):
        h = torch.einsum("bsd,df->bsf", x, w1)
        zero = torch.zeros_like(h)
        h = torch.maximum(h, zero)
        return torch.einsum("bsf,fd->bsd", h, w2)

    x = A_x
    xn = _layernorm(x, axis=-1)
    s = _A_ref(xn, A_wqkv, A_wo)
    g = _silu(_B_ref(xn, B_w1, B_w2))
    return x + s * g
```

```asm
; @launch kernel=ln_kernel grid=(512,1,1) block=(256,1,1) lds=0
; @launch kernel=gemm1_kernel grid=(216,1,1) block=(512,1,1) lds=147456
; @launch kernel=attn_kernel grid=(512,1,1) block=(256,1,1) lds=35840
; @launch kernel=gemm2_kernel grid=(160,1,1) block=(256,1,1) lds=122880
.amdgcn_target "amdgcn-amd-amdhsa--gfx950"
.text
.globl ln_kernel
.p2align 8
.type ln_kernel,@function
ln_kernel:
    s_cmp_ge_u32 s2, 512
    s_cbranch_scc1 L_ln_end_1
    s_load_dwordx2 s[4:5], s[0:1], 0
    s_load_dwordx2 s[6:7], s[0:1], 64
    v_lshrrev_b32 v1, 6, v0
    v_and_b32 v2, 63, v0
    s_lshl_b32 s3, s2, 2
    v_add_u32 v1, s3, v1
    v_mul_u32_u24 v3, 1280, v1
    v_mul_u32_u24 v4, 20, v2
    v_add_u32 v3, v3, v4
    s_waitcnt lgkmcnt(0)
    s_mov_b32 s8, s4
    s_and_b32 s9, s5, 0xffff
    s_mov_b32 s10, 0x280000
    s_mov_b32 s11, 0x20000
    s_add_u32 s12, s6, 0x0
    s_addc_u32 s13, s7, 0
    s_and_b32 s13, s13, 0xffff
    s_mov_b32 s14, 0x280000
    s_mov_b32 s15, 0x20000
    buffer_load_dwordx4 v[8:11], v3, s[8:11], 0 offen
    buffer_load_dword v12, v3, s[8:11], 0 offen offset:16
    s_waitcnt vmcnt(0)
    v_lshlrev_b32 v16, 16, v8
    v_and_b32 v17, 0xffff0000, v8
    v_lshlrev_b32 v18, 16, v9
    v_and_b32 v19, 0xffff0000, v9
    v_lshlrev_b32 v20, 16, v10
    v_and_b32 v21, 0xffff0000, v10
    v_lshlrev_b32 v22, 16, v11
    v_and_b32 v23, 0xffff0000, v11
    v_lshlrev_b32 v24, 16, v12
    v_and_b32 v25, 0xffff0000, v12
    v_add_f32 v30, v16, v17
    v_add_f32 v30, v30, v18
    v_add_f32 v30, v30, v19
    v_add_f32 v30, v30, v20
    v_add_f32 v30, v30, v21
    v_add_f32 v30, v30, v22
    v_add_f32 v30, v30, v23
    v_add_f32 v30, v30, v24
    v_add_f32 v30, v30, v25
    ds_swizzle_b32 v31, v30 offset:0x041f
    s_waitcnt lgkmcnt(0)
    v_add_f32 v30, v30, v31
    ds_swizzle_b32 v31, v30 offset:0x081f
    s_waitcnt lgkmcnt(0)
    v_add_f32 v30, v30, v31
    ds_swizzle_b32 v31, v30 offset:0x101f
    s_waitcnt lgkmcnt(0)
    v_add_f32 v30, v30, v31
    ds_swizzle_b32 v31, v30 offset:0x201f
    s_waitcnt lgkmcnt(0)
    v_add_f32 v30, v30, v31
    ds_swizzle_b32 v31, v30 offset:0x401f
    s_waitcnt lgkmcnt(0)
    v_add_f32 v30, v30, v31
    s_nop 0
    v_readlane_b32 s40, v30, 0
    v_readlane_b32 s41, v30, 32
    s_nop 1
    v_mov_b32 v30, s40
    v_add_f32 v30, s41, v30
    v_mul_f32 v30, 0x3acccccd, v30
    v_sub_f32 v32, v16, v30
    v_mul_f32 v33, v32, v32
    v_sub_f32 v32, v17, v30
    v_fmac_f32 v33, v32, v32
    v_sub_f32 v32, v18, v30
    v_fmac_f32 v33, v32, v32
    v_sub_f32 v32, v19, v30
    v_fmac_f32 v33, v32, v32
    v_sub_f32 v32, v20, v30
    v_fmac_f32 v33, v32, v32
    v_sub_f32 v32, v21, v30
    v_fmac_f32 v33, v32, v32
    v_sub_f32 v32, v22, v30
    v_fmac_f32 v33, v32, v32
    v_sub_f32 v32, v23, v30
    v_fmac_f32 v33, v32, v32
    v_sub_f32 v32, v24, v30
    v_fmac_f32 v33, v32, v32
    v_sub_f32 v32, v25, v30
    v_fmac_f32 v33, v32, v32
    ds_swizzle_b32 v31, v33 offset:0x041f
    s_waitcnt lgkmcnt(0)
    v_add_f32 v33, v33, v31
    ds_swizzle_b32 v31, v33 offset:0x081f
    s_waitcnt lgkmcnt(0)
    v_add_f32 v33, v33, v31
    ds_swizzle_b32 v31, v33 offset:0x101f
    s_waitcnt lgkmcnt(0)
    v_add_f32 v33, v33, v31
    ds_swizzle_b32 v31, v33 offset:0x201f
    s_waitcnt lgkmcnt(0)
    v_add_f32 v33, v33, v31
    ds_swizzle_b32 v31, v33 offset:0x401f
    s_waitcnt lgkmcnt(0)
    v_add_f32 v33, v33, v31
    s_nop 0
    v_readlane_b32 s40, v33, 0
    v_readlane_b32 s41, v33, 32
    s_nop 1
    v_mov_b32 v33, s40
    v_add_f32 v33, s41, v33
    v_mul_f32 v33, 0x3acccccd, v33
    v_cvt_pk_bf16_f32 v33, v33, v33
    v_lshlrev_b32 v33, 16, v33
    v_add_f32 v33, 0x3727c5ac, v33
    v_cvt_pk_bf16_f32 v33, v33, v33
    v_lshlrev_b32 v33, 16, v33
    v_sqrt_f32 v33, v33
    s_nop 0
    v_cvt_pk_bf16_f32 v33, v33, v33
    v_lshlrev_b32 v33, 16, v33
    v_cvt_pk_bf16_f32 v30, v30, v30
    v_lshlrev_b32 v30, 16, v30
    v_rcp_f32 v34, v33
    s_nop 0
    v_fma_f32 v35, -v33, v34, 1.0
    v_fma_f32 v34, v35, v34, v34
    v_sub_f32 v16, v16, v30
    v_sub_f32 v17, v17, v30
    v_sub_f32 v18, v18, v30
    v_sub_f32 v19, v19, v30
    v_sub_f32 v20, v20, v30
    v_sub_f32 v21, v21, v30
    v_sub_f32 v22, v22, v30
    v_sub_f32 v23, v23, v30
    v_sub_f32 v24, v24, v30
    v_sub_f32 v25, v25, v30
    v_cvt_pk_bf16_f32 v8, v16, v17
    v_cvt_pk_bf16_f32 v9, v18, v19
    v_cvt_pk_bf16_f32 v10, v20, v21
    v_cvt_pk_bf16_f32 v11, v22, v23
    v_cvt_pk_bf16_f32 v12, v24, v25
    v_lshlrev_b32 v16, 16, v8
    v_and_b32 v17, 0xffff0000, v8
    v_lshlrev_b32 v18, 16, v9
    v_and_b32 v19, 0xffff0000, v9
    v_lshlrev_b32 v20, 16, v10
    v_and_b32 v21, 0xffff0000, v10
    v_lshlrev_b32 v22, 16, v11
    v_and_b32 v23, 0xffff0000, v11
    v_lshlrev_b32 v24, 16, v12
    v_and_b32 v25, 0xffff0000, v12
    v_mul_f32 v36, v16, v34
    v_fma_f32 v37, -v36, v33, v16
    v_fma_f32 v16, v37, v34, v36
    v_mul_f32 v36, v17, v34
    v_fma_f32 v37, -v36, v33, v17
    v_fma_f32 v17, v37, v34, v36
    v_mul_f32 v36, v18, v34
    v_fma_f32 v37, -v36, v33, v18
    v_fma_f32 v18, v37, v34, v36
    v_mul_f32 v36, v19, v34
    v_fma_f32 v37, -v36, v33, v19
    v_fma_f32 v19, v37, v34, v36
    v_mul_f32 v36, v20, v34
    v_fma_f32 v37, -v36, v33, v20
    v_fma_f32 v20, v37, v34, v36
    v_mul_f32 v36, v21, v34
    v_fma_f32 v37, -v36, v33, v21
    v_fma_f32 v21, v37, v34, v36
    v_mul_f32 v36, v22, v34
    v_fma_f32 v37, -v36, v33, v22
    v_fma_f32 v22, v37, v34, v36
    v_mul_f32 v36, v23, v34
    v_fma_f32 v37, -v36, v33, v23
    v_fma_f32 v23, v37, v34, v36
    v_mul_f32 v36, v24, v34
    v_fma_f32 v37, -v36, v33, v24
    v_fma_f32 v24, v37, v34, v36
    v_mul_f32 v36, v25, v34
    v_fma_f32 v37, -v36, v33, v25
    v_fma_f32 v25, v37, v34, v36
    v_cvt_pk_bf16_f32 v8, v16, v17
    v_cvt_pk_bf16_f32 v9, v18, v19
    v_cvt_pk_bf16_f32 v10, v20, v21
    v_cvt_pk_bf16_f32 v11, v22, v23
    v_cvt_pk_bf16_f32 v12, v24, v25
    buffer_store_dwordx4 v[8:11], v3, s[12:15], 0 offen
    buffer_store_dword v12, v3, s[12:15], 0 offen offset:16
L_ln_end_1:
    s_endpgm
.globl gemm1_kernel
.p2align 8
.type gemm1_kernel,@function
gemm1_kernel:
    s_cmp_ge_u32 s2, 216
    s_cbranch_scc1 L_g1_end_2
    s_load_dwordx2 s[4:5], s[0:1], 8
    s_load_dwordx2 s[6:7], s[0:1], 32
    s_load_dwordx2 s[8:9], s[0:1], 64
    s_and_b32 s24, s2, 7
    s_lshr_b32 s25, s2, 3
    v_lshrrev_b32 v1, 6, v0
    s_nop 0
    v_readfirstlane_b32 s26, v1
    v_and_b32 v2, 63, v0
    s_waitcnt lgkmcnt(0)
    s_add_u32 s12, s8, 0x0
    s_addc_u32 s13, s9, 0
    s_and_b32 s13, s13, 0xffff
    s_mov_b32 s14, 0x280000
    s_mov_b32 s15, 0x20000
    s_cmp_ge_u32 s25, 15
    s_cbranch_scc1 L_g1_w1_3
    s_mov_b32 s16, s4
    s_and_b32 s17, s5, 0xffff
    s_mov_b32 s18, 0x258000
    s_mov_b32 s19, 0x20000
    s_movk_i32 s27, 3840
    s_lshl_b32 s28, s25, 8
    s_branch L_g1_wdone_4
L_g1_w1_3:
    s_mov_b32 s16, s6
    s_and_b32 s17, s7, 0xffff
    s_mov_b32 s18, 0x1e0000
    s_mov_b32 s19, 0x20000
    s_movk_i32 s27, 3072
    s_sub_u32 s28, s25, 15
    s_lshl_b32 s28, s28, 8
L_g1_wdone_4:
    s_lshr_b32 s29, s26, 1
    s_and_b32 s30, s26, 1
    v_and_b32 v3, 31, v2
    v_lshrrev_b32 v4, 5, v2
    s_lshl_b32 s31, s24, 8
    s_lshl_b32 s32, s29, 6
    s_add_u32 s31, s31, s32
    v_add_u32 v5, s31, v3
    v_lshrrev_b32 v8, 3, v2
    v_lshrrev_b32 v9, 4, v2
    s_and_b32 s33, s26, 1
    s_lshl_b32 s33, s33, 2
    v_add_u32 v9, s33, v9
    v_and_b32 v10, 7, v2
    v_xor_b32 v9, v9, v10
    v_lshlrev_b32 v9, 4, v9
    v_mul_u32_u24 v8, 1280, v8
    v_add_u32 v8, v8, v9
    s_lshl_b32 s34, s24, 8
    s_lshl_b32 s35, s26, 3
    s_add_u32 s34, s34, s35
    s_mul_i32 s40, s34, 1280
    s_add_u32 s41, s40, 81920
    s_add_u32 s42, s40, 163840
    s_add_u32 s43, s40, 245760
    s_lshl_b32 s36, s26, 10
    v_lshrrev_b32 v9, 4, v2
    v_and_b32 v10, 15, v2
    v_lshlrev_b32 v11, 2, v9
    v_xor_b32 v10, v10, v11
    v_lshlrev_b32 v10, 4, v10
    v_mul_lo_u32 v11, v9, s27
    v_add3_u32 v9, v10, v11, s28
    s_lshl_b32 s44, s26, 3
    s_mul_i32 s44, s44, s27
    s_lshl_b32 s45, s27, 2
    s_add_u32 s45, s44, s45
    s_lshl_b32 s46, s27, 6
    s_lshl_b32 s37, s26, 11
    v_add_u32 v10, s32, v3
    v_bfe_u32 v11, v10, 1, 3
    v_lshlrev_b32 v12, 2, v4
    v_xor_b32 v11, v11, v12
    v_lshlrev_b32 v10, 7, v10
    v_xor_b32 v12, 0, v11
    v_lshl_add_u32 v16, v12, 4, v10
    v_xor_b32 v12, 1, v11
    v_lshl_add_u32 v17, v12, 4, v10
    v_xor_b32 v12, 2, v11
    v_lshl_add_u32 v18, v12, 4, v10
    v_xor_b32 v12, 3, v11
    v_lshl_add_u32 v19, v12, 4, v10
    v_bfe_u32 v10, v2, 2, 2
    v_and_b32 v11, 3, v2
    v_bfe_u32 v12, v2, 4, 1
    v_lshl_add_u32 v13, v4, 5, v10
    v_lshlrev_b32 v13, 8, v13
    v_lshl_add_u32 v13, v12, 5, v13
    v_lshl_add_u32 v13, v11, 3, v13
    s_lshl_b32 s38, s30, 1
    v_xor_b32 v14, s38, v10
    v_lshl_add_u32 v14, v14, 6, v13
    s_add_u32 s38, s38, 1
    v_xor_b32 v15, s38, v10
    v_lshl_add_u32 v15, v15, 6, v13
    s_cmp_lt_u32 s25, 10
    s_cbranch_scc1 L_g1_q_6
    s_cmp_lt_u32 s25, 15
    s_cbranch_scc1 L_g1_v_5
L_g1_q_6:
    v_add_u32 v22, 0xc000, v16
    v_add_u32 v23, 0xc000, v17
    v_add_u32 v24, 0xc000, v18
    v_add_u32 v25, 0xc000, v19
    v_add_u32 v20, 0xc000, v14
    v_add_u32 v21, 0xc000, v15
    v_add_u32 v28, 0x18000, v16
    v_add_u32 v29, 0x18000, v17
    v_add_u32 v30, 0x18000, v18
    v_add_u32 v31, 0x18000, v19
    v_add_u32 v26, 0x18000, v14
    v_add_u32 v27, 0x18000, v15
    s_add_u32 m0, s36, 0x0
    s_nop 0
    buffer_load_dwordx4 v8, s[12:15], s40 offen lds
    s_add_u32 s40, s40, 128
    s_add_u32 m0, s36, 0x2000
    s_nop 0
    buffer_load_dwordx4 v8, s[12:15], s41 offen lds
    s_add_u32 s41, s41, 128
    s_add_u32 m0, s36, 0x4000
    s_nop 0
    buffer_load_dwordx4 v8, s[12:15], s42 offen lds
    s_add_u32 s42, s42, 128
    s_add_u32 m0, s36, 0x6000
    s_nop 0
    buffer_load_dwordx4 v8, s[12:15], s43 offen lds
    s_add_u32 s43, s43, 128
    s_add_u32 m0, s37, 0x8000
    s_nop 0
    buffer_load_dwordx4 v9, s[16:19], s44 offen lds
    s_add_u32 s44, s44, s46
    s_add_u32 m0, s37, 0x8400
    s_nop 0
    buffer_load_dwordx4 v9, s[16:19], s45 offen lds
    s_add_u32 s45, s45, s46
    s_add_u32 m0, s36, 0xc000
    s_nop 0
    buffer_load_dwordx4 v8, s[12:15], s40 offen lds
    s_add_u32 s40, s40, 128
    s_add_u32 m0, s36, 0xe000
    s_nop 0
    buffer_load_dwordx4 v8, s[12:15], s41 offen lds
    s_add_u32 s41, s41, 128
    s_add_u32 m0, s36, 0x10000
    s_nop 0
    buffer_load_dwordx4 v8, s[12:15], s42 offen lds
    s_add_u32 s42, s42, 128
    s_add_u32 m0, s36, 0x12000
    s_nop 0
    buffer_load_dwordx4 v8, s[12:15], s43 offen lds
    s_add_u32 s43, s43, 128
    s_add_u32 m0, s37, 0x14000
    s_nop 0
    buffer_load_dwordx4 v9, s[16:19], s44 offen lds
    s_add_u32 s44, s44, s46
    s_add_u32 m0, s37, 0x14400
    s_nop 0
    buffer_load_dwordx4 v9, s[16:19], s45 offen lds
    s_add_u32 s45, s45, s46
    s_waitcnt vmcnt(6)
    s_barrier
    s_add_u32 m0, s36, 0x18000
    s_nop 0
    buffer_load_dwordx4 v8, s[12:15], s40 offen lds
    s_add_u32 s40, s40, 128
    s_add_u32 m0, s36, 0x1a000
    s_nop 0
    buffer_load_dwordx4 v8, s[12:15], s41 offen lds
    s_add_u32 s41, s41, 128
    s_add_u32 m0, s36, 0x1c000
    s_nop 0
    buffer_load_dwordx4 v8, s[12:15], s42 offen lds
    s_add_u32 s42, s42, 128
    s_add_u32 m0, s36, 0x1e000
    s_nop 0
    buffer_load_dwordx4 v8, s[12:15], s43 offen lds
    s_add_u32 s43, s43, 128
    s_add_u32 m0, s37, 0x20000
    s_nop 0
    buffer_load_dwordx4 v9, s[16:19], s44 offen lds
    s_add_u32 s44, s44, s46
    s_add_u32 m0, s37, 0x20400
    s_nop 0
    buffer_load_dwordx4 v9, s[16:19], s45 offen lds
    s_add_u32 s45, s45, s46
    ds_read_b128 v[32:35], v16 offset:0
    ds_read_b128 v[36:39], v16 offset:4096
    ds_read_b64_tr_b16 v[48:49], v14 offset:32768
    ds_read_b64_tr_b16 v[50:51], v14 offset:33792
    ds_read_b64_tr_b16 v[52:53], v15 offset:32768
    ds_read_b64_tr_b16 v[54:55], v15 offset:33792
    ds_read_b128 v[40:43], v17 offset:0
    ds_read_b128 v[44:47], v17 offset:4096
    ds_read_b64_tr_b16 v[56:57], v14 offset:34816
    ds_read_b64_tr_b16 v[58:59], v14 offset:35840
    ds_read_b64_tr_b16 v[60:61], v15 offset:34816
    ds_read_b64_tr_b16 v[62:63], v15 offset:35840
    s_waitcnt lgkmcnt(6)
    v_mfma_f32_32x32x16_bf16 v[64:79], v[48:51], v[32:35], 0
    v_mfma_f32_32x32x16_bf16 v[80:95], v[52:55], v[32:35], 0
    v_mfma_f32_32x32x16_bf16 v[96:111], v[48:51], v[36:39], 0
    v_mfma_f32_32x32x16_bf16 v[112:127], v[52:55], v[36:39], 0
    ds_read_b128 v[32:35], v18 offset:0
    ds_read_b128 v[36:39], v18 offset:4096
    ds_read_b64_tr_b16 v[48:49], v14 offset:36864
    ds_read_b64_tr_b16 v[50:51], v14 offset:37888
    ds_read_b64_tr_b16 v[52:53], v15 offset:36864
    ds_read_b64_tr_b16 v[54:55], v15 offset:37888
    s_waitcnt lgkmcnt(6)
    v_mfma_f32_32x32x16_bf16 v[64:79], v[56:59], v[40:43], v[64:79]
    v_mfma_f32_32x32x16_bf16 v[80:95], v[60:63], v[40:43], v[80:95]
    v_mfma_f32_32x32x16_bf16 v[96:111], v[56:59], v[44:47], v[96:111]
    v_mfma_f32_32x32x16_bf16 v[112:127], v[60:63], v[44:47], v[112:127]
    ds_read_b128 v[40:43], v19 offset:0
    ds_read_b128 v[44:47], v19 offset:4096
    ds_read_b64_tr_b16 v[56:57], v14 offset:38912
    ds_read_b64_tr_b16 v[58:59], v14 offset:39936
    ds_read_b64_tr_b16 v[60:61], v15 offset:38912
    ds_read_b64_tr_b16 v[62:63], v15 offset:39936
    s_waitcnt lgkmcnt(6)
    v_mfma_f32_32x32x16_bf16 v[64:79], v[48:51], v[32:35], v[64:79]
    v_mfma_f32_32x32x16_bf16 v[80:95], v[52:55], v[32:35], v[80:95]
    v_mfma_f32_32x32x16_bf16 v[96:111], v[48:51], v[36:39], v[96:111]
    v_mfma_f32_32x32x16_bf16 v[112:127], v[52:55], v[36:39], v[112:127]
    s_waitcnt lgkmcnt(0)
    v_mfma_f32_32x32x16_bf16 v[64:79], v[56:59], v[40:43], v[64:79]
    v_mfma_f32_32x32x16_bf16 v[80:95], v[60:63], v[40:43], v[80:95]
    v_mfma_f32_32x32x16_bf16 v[96:111], v[56:59], v[44:47], v[96:111]
    v_mfma_f32_32x32x16_bf16 v[112:127], v[60:63], v[44:47], v[112:127]
    s_waitcnt vmcnt(6)
    s_barrier
    s_add_u32 m0, s36, 0x0
    s_nop 0
    buffer_load_dwordx4 v8, s[12:15], s40 offen lds
    s_add_u32 s40, s40, 128
    s_add_u32 m0, s36, 0x2000
    s_nop 0
    buffer_load_dwordx4 v8, s[12:15], s41 offen lds
    s_add_u32 s41, s41, 128
    s_add_u32 m0, s36, 0x4000
    s_nop 0
    buffer_load_dwordx4 v8, s[12:15], s42 offen lds
    s_add_u32 s42, s42, 128
    s_add_u32 m0, s36, 0x6000
    s_nop 0
    buffer_load_dwordx4 v8, s[12:15], s43 offen lds
    s_add_u32 s43, s43, 128
    s_add_u32 m0, s37, 0x8000
    s_nop 0
    buffer_load_dwordx4 v9, s[16:19], s44 offen lds
    s_add_u32 s44, s44, s46
    s_add_u32 m0, s37, 0x8400
    s_nop 0
    buffer_load_dwordx4 v9, s[16:19], s45 offen lds
    s_add_u32 s45, s45, s46
    ds_read_b128 v[32:35], v22 offset:0
    ds_read_b128 v[36:39], v22 offset:4096
    ds_read_b64_tr_b16 v[48:49], v20 offset:32768
    ds_read_b64_tr_b16 v[50:51], v20 offset:33792
    ds_read_b64_tr_b16 v[52:53], v21 offset:32768
    ds_read_b64_tr_b16 v[54:55], v21 offset:33792
    ds_read_b128 v[40:43], v23 offset:0
    ds_read_b128 v[44:47], v23 offset:4096
    ds_read_b64_tr_b16 v[56:57], v20 offset:34816
    ds_read_b64_tr_b16 v[58:59], v20 offset:35840
    ds_read_b64_tr_b16 v[60:61], v21 offset:34816
    ds_read_b64_tr_b16 v[62:63], v21 offset:35840
    s_waitcnt lgkmcnt(6)
    v_mfma_f32_32x32x16_bf16 v[64:79], v[48:51], v[32:35], v[64:79]
    v_mfma_f32_32x32x16_bf16 v[80:95], v[52:55], v[32:35], v[80:95]
    v_mfma_f32_32x32x16_bf16 v[96:111], v[48:51], v[36:39], v[96:111]
    v_mfma_f32_32x32x16_bf16 v[112:127], v[52:55], v[36:39], v[112:127]
    ds_read_b128 v[32:35], v24 offset:0
    ds_read_b128 v[36:39], v24 offset:4096
    ds_read_b64_tr_b16 v[48:49], v20 offset:36864
    ds_read_b64_tr_b16 v[50:51], v20 offset:37888
    ds_read_b64_tr_b16 v[52:53], v21 offset:36864
    ds_read_b64_tr_b16 v[54:55], v21 offset:37888
    s_waitcnt lgkmcnt(6)
    v_mfma_f32_32x32x16_bf16 v[64:79], v[56:59], v[40:43], v[64:79]
    v_mfma_f32_32x32x16_bf16 v[80:95], v[60:63], v[40:43], v[80:95]
    v_mfma_f32_32x32x16_bf16 v[96:111], v[56:59], v[44:47], v[96:111]
    v_mfma_f32_32x32x16_bf16 v[112:127], v[60:63], v[44:47], v[112:127]
    ds_read_b128 v[40:43], v25 offset:0
    ds_read_b128 v[44:47], v25 offset:4096
    ds_read_b64_tr_b16 v[56:57], v20 offset:38912
    ds_read_b64_tr_b16 v[58:59], v20 offset:39936
    ds_read_b64_tr_b16 v[60:61], v21 offset:38912
    ds_read_b64_tr_b16 v[62:63], v21 offset:39936
    s_waitcnt lgkmcnt(6)
    v_mfma_f32_32x32x16_bf16 v[64:79], v[48:51], v[32:35], v[64:79]
    v_mfma_f32_32x32x16_bf16 v[80:95], v[52:55], v[32:35], v[80:95]
    v_mfma_f32_32x32x16_bf16 v[96:111], v[48:51], v[36:39], v[96:111]
    v_mfma_f32_32x32x16_bf16 v[112:127], v[52:55], v[36:39], v[112:127]
    s_waitcnt lgkmcnt(0)
    v_mfma_f32_32x32x16_bf16 v[64:79], v[56:59], v[40:43], v[64:79]
    v_mfma_f32_32x32x16_bf16 v[80:95], v[60:63], v[40:43], v[80:95]
    v_mfma_f32_32x32x16_bf16 v[96:111], v[56:59], v[44:47], v[96:111]
    v_mfma_f32_32x32x16_bf16 v[112:127], v[60:63], v[44:47], v[112:127]
    s_waitcnt vmcnt(6)
    s_barrier
    s_add_u32 m0, s36, 0xc000
    s_nop 0
    buffer_load_dwordx4 v8, s[12:15], s40 offen lds
    s_add_u32 s40, s40, 128
    s_add_u32 m0, s36, 0xe000
    s_nop 0
    buffer_load_dwordx4 v8, s[12:15], s41 offen lds
    s_add_u32 s41, s41, 128
    s_add_u32 m0, s36, 0x10000
    s_nop 0
    buffer_load_dwordx4 v8, s[12:15], s42 offen lds
    s_add_u32 s42, s42, 128
    s_add_u32 m0, s36, 0x12000
    s_nop 0
    buffer_load_dwordx4 v8, s[12:15], s43 offen lds
    s_add_u32 s43, s43, 128
    s_add_u32 m0, s37, 0x14000
    s_nop 0
    buffer_load_dwordx4 v9, s[16:19], s44 offen lds
    s_add_u32 s44, s44, s46
    s_add_u32 m0, s37, 0x14400
    s_nop 0
    buffer_load_dwordx4 v9, s[16:19], s45 offen lds
    s_add_u32 s45, s45, s46
    ds_read_b128 v[32:35], v28 offset:0
    ds_read_b128 v[36:39], v28 offset:4096
    ds_read_b64_tr_b16 v[48:49], v26 offset:32768
    ds_read_b64_tr_b16 v[50:51], v26 offset:33792
    ds_read_b64_tr_b16 v[52:53], v27 offset:32768
    ds_read_b64_tr_b16 v[54:55], v27 offset:33792
    ds_read_b128 v[40:43], v29 offset:0
    ds_read_b128 v[44:47], v29 offset:4096
    ds_read_b64_tr_b16 v[56:57], v26 offset:34816
    ds_read_b64_tr_b16 v[58:59], v26 offset:35840
    ds_read_b64_tr_b16 v[60:61], v27 offset:34816
    ds_read_b64_tr_b16 v[62:63], v27 offset:35840
    s_waitcnt lgkmcnt(6)
    v_mfma_f32_32x32x16_bf16 v[64:79], v[48:51], v[32:35], v[64:79]
    v_mfma_f32_32x32x16_bf16 v[80:95], v[52:55], v[32:35], v[80:95]
    v_mfma_f32_32x32x16_bf16 v[96:111], v[48:51], v[36:39], v[96:111]
    v_mfma_f32_32x32x16_bf16 v[112:127], v[52:55], v[36:39], v[112:127]
    ds_read_b128 v[32:35], v30 offset:0
    ds_read_b128 v[36:39], v30 offset:4096
    ds_read_b64_tr_b16 v[48:49], v26 offset:36864
    ds_read_b64_tr_b16 v[50:51], v26 offset:37888
    ds_read_b64_tr_b16 v[52:53], v27 offset:36864
    ds_read_b64_tr_b16 v[54:55], v27 offset:37888
    s_waitcnt lgkmcnt(6)
    v_mfma_f32_32x32x16_bf16 v[64:79], v[56:59], v[40:43], v[64:79]
    v_mfma_f32_32x32x16_bf16 v[80:95], v[60:63], v[40:43], v[80:95]
    v_mfma_f32_32x32x16_bf16 v[96:111], v[56:59], v[44:47], v[96:111]
    v_mfma_f32_32x32x16_bf16 v[112:127], v[60:63], v[44:47], v[112:127]
    ds_read_b128 v[40:43], v31 offset:0
    ds_read_b128 v[44:47], v31 offset:4096
    ds_read_b64_tr_b16 v[56:57], v26 offset:38912
    ds_read_b64_tr_b16 v[58:59], v26 offset:39936
    ds_read_b64_tr_b16 v[60:61], v27 offset:38912
    ds_read_b64_tr_b16 v[62:63], v27 offset:39936
    s_waitcnt lgkmcnt(6)
    v_mfma_f32_32x32x16_bf16 v[64:79], v[48:51], v[32:35], v[64:79]
    v_mfma_f32_32x32x16_bf16 v[80:95], v[52:55], v[32:35], v[80:95]
    v_mfma_f32_32x32x16_bf16 v[96:111], v[48:51], v[36:39], v[96:111]
    v_mfma_f32_32x32x16_bf16 v[112:127], v[52:55], v[36:39], v[112:127]
    s_waitcnt lgkmcnt(0)
    v_mfma_f32_32x32x16_bf16 v[64:79], v[56:59], v[40:43], v[64:79]
    v_mfma_f32_32x32x16_bf16 v[80:95], v[60:63], v[40:43], v[80:95]
    v_mfma_f32_32x32x16_bf16 v[96:111], v[56:59], v[44:47], v[96:111]
    v_mfma_f32_32x32x16_bf16 v[112:127], v[60:63], v[44:47], v[112:127]
    s_waitcnt vmcnt(6)
    s_barrier
    s_add_u32 m0, s36, 0x18000
    s_nop 0
    buffer_load_dwordx4 v8, s[12:15], s40 offen lds
    s_add_u32 s40, s40, 128
    s_add_u32 m0, s36, 0x1a000
    s_nop 0
    buffer_load_dwordx4 v8, s[12:15], s41 offen lds
    s_add_u32 s41, s41, 128
    s_add_u32 m0, s36, 0x1c000
    s_nop 0
    buffer_load_dwordx4 v8, s[12:15], s42 offen lds
    s_add_u32 s42, s42, 128
    s_add_u32 m0, s36, 0x1e000
    s_nop 0
    buffer_load_dwordx4 v8, s[12:15], s43 offen lds
    s_add_u32 s43, s43, 128
    s_add_u32 m0, s37, 0x20000
    s_nop 0
    buffer_load_dwordx4 v9, s[16:19], s44 offen lds
    s_add_u32 s44, s44, s46
    s_add_u32 m0, s37, 0x20400
    s_nop 0
    buffer_load_dwordx4 v9, s[16:19], s45 offen lds
    s_add_u32 s45, s45, s46
    ds_read_b128 v[32:35], v16 offset:0
    ds_read_b128 v[36:39], v16 offset:4096
    ds_read_b64_tr_b16 v[48:49], v14 offset:32768
    ds_read_b64_tr_b16 v[50:51], v14 offset:33792
    ds_read_b64_tr_b16 v[52:53], v15 offset:32768
    ds_read_b64_tr_b16 v[54:55], v15 offset:33792
    ds_read_b128 v[40:43], v17 offset:0
    ds_read_b128 v[44:47], v17 offset:4096
    ds_read_b64_tr_b16 v[56:57], v14 offset:34816
    ds_read_b64_tr_b16 v[58:59], v14 offset:35840
    ds_read_b64_tr_b16 v[60:61], v15 offset:34816
    ds_read_b64_tr_b16 v[62:63], v15 offset:35840
    s_waitcnt lgkmcnt(6)
    v_mfma_f32_32x32x16_bf16 v[64:79], v[48:51], v[32:35], v[64:79]
    v_mfma_f32_32x32x16_bf16 v[80:95], v[52:55], v[32:35], v[80:95]
    v_mfma_f32_32x32x16_bf16 v[96:111], v[48:51], v[36:39], v[96:111]
    v_mfma_f32_32x32x16_bf16 v[112:127], v[52:55], v[36:39], v[112:127]
    ds_read_b128 v[32:35], v18 offset:0
    ds_read_b128 v[36:39], v18 offset:4096
    ds_read_b64_tr_b16 v[48:49], v14 offset:36864
    ds_read_b64_tr_b16 v[50:51], v14 offset:37888
    ds_read_b64_tr_b16 v[52:53], v15 offset:36864
    ds_read_b64_tr_b16 v[54:55], v15 offset:37888
    s_waitcnt lgkmcnt(6)
    v_mfma_f32_32x32x16_bf16 v[64:79], v[56:59], v[40:43], v[64:79]
    v_mfma_f32_32x32x16_bf16 v[80:95], v[60:63], v[40:43], v[80:95]
    v_mfma_f32_32x32x16_bf16 v[96:111], v[56:59], v[44:47], v[96:111]
    v_mfma_f32_32x32x16_bf16 v[112:127], v[60:63], v[44:47], v[112:127]
    ds_read_b128 v[40:43], v19 offset:0
    ds_read_b128 v[44:47], v19 offset:4096
    ds_read_b64_tr_b16 v[56:57], v14 offset:38912
    ds_read_b64_tr_b16 v[58:59], v14 offset:39936
    ds_read_b64_tr_b16 v[60:61], v15 offset:38912
    ds_read_b64_tr_b16 v[62:63], v15 offset:39936
    s_waitcnt lgkmcnt(6)
    v_mfma_f32_32x32x16_bf16 v[64:79], v[48:51], v[32:35], v[64:79]
    v_mfma_f32_32x32x16_bf16 v[80:95], v[52:55], v[32:35], v[80:95]
    v_mfma_f32_32x32x16_bf16 v[96:111], v[48:51], v[36:39], v[96:111]
    v_mfma_f32_32x32x16_bf16 v[112:127], v[52:55], v[36:39], v[112:127]
    s_waitcnt lgkmcnt(0)
    v_mfma_f32_32x32x16_bf16 v[64:79], v[56:59], v[40:43], v[64:79]
    v_mfma_f32_32x32x16_bf16 v[80:95], v[60:63], v[40:43], v[80:95]
    v_mfma_f32_32x32x16_bf16 v[96:111], v[56:59], v[44:47], v[96:111]
    v_mfma_f32_32x32x16_bf16 v[112:127], v[60:63], v[44:47], v[112:127]
    s_waitcnt vmcnt(6)
    s_barrier
    s_add_u32 m0, s36, 0x0
    s_nop 0
    buffer_load_dwordx4 v8, s[12:15], s40 offen lds
    s_add_u32 s40, s40, 128
    s_add_u32 m0, s36, 0x2000
    s_nop 0
    buffer_load_dwordx4 v8, s[12:15], s41 offen lds
    s_add_u32 s41, s41, 128
    s_add_u32 m0, s36, 0x4000
    s_nop 0
    buffer_load_dwordx4 v8, s[12:15], s42 offen lds
    s_add_u32 s42, s42, 128
    s_add_u32 m0, s36, 0x6000
    s_nop 0
    buffer_load_dwordx4 v8, s[12:15], s43 offen lds
    s_add_u32 s43, s43, 128
    s_add_u32 m0, s37, 0x8000
    s_nop 0
    buffer_load_dwordx4 v9, s[16:19], s44 offen lds
    s_add_u32 s44, s44, s46
    s_add_u32 m0, s37, 0x8400
    s_nop 0
    buffer_load_dwordx4 v9, s[16:19], s45 offen lds
    s_add_u32 s45, s45, s46
    ds_read_b128 v[32:35], v22 offset:0
    ds_read_b128 v[36:39], v22 offset:4096
    ds_read_b64_tr_b16 v[48:49], v20 offset:32768
    ds_read_b64_tr_b16 v[50:51], v20 offset:33792
    ds_read_b64_tr_b16 v[52:53], v21 offset:32768
    ds_read_b64_tr_b16 v[54:55], v21 offset:33792
    ds_read_b128 v[40:43], v23 offset:0
    ds_read_b128 v[44:47], v23 offset:4096
    ds_read_b64_tr_b16 v[56:57], v20 offset:34816
    ds_read_b64_tr_b16 v[58:59], v20 offset:35840
    ds_read_b64_tr_b16 v[60:61], v21 offset:34816
    ds_read_b64_tr_b16 v[62:63], v21 offset:35840
    s_waitcnt lgkmcnt(6)
    v_mfma_f32_32x32x16_bf16 v[64:79], v[48:51], v[32:35], v[64:79]
    v_mfma_f32_32x32x16_bf16 v[80:95], v[52:55], v[32:35], v[80:95]
    v_mfma_f32_32x32x16_bf16 v[96:111], v[48:51], v[36:39], v[96:111]
    v_mfma_f32_32x32x16_bf16 v[112:127], v[52:55], v[36:39], v[112:127]
    ds_read_b128 v[32:35], v24 offset:0
    ds_read_b128 v[36:39], v24 offset:4096
    ds_read_b64_tr_b16 v[48:49], v20 offset:36864
    ds_read_b64_tr_b16 v[50:51], v20 offset:37888
    ds_read_b64_tr_b16 v[52:53], v21 offset:36864
    ds_read_b64_tr_b16 v[54:55], v21 offset:37888
    s_waitcnt lgkmcnt(6)
    v_mfma_f32_32x32x16_bf16 v[64:79], v[56:59], v[40:43], v[64:79]
    v_mfma_f32_32x32x16_bf16 v[80:95], v[60:63], v[40:43], v[80:95]
    v_mfma_f32_32x32x16_bf16 v[96:111], v[56:59], v[44:47], v[96:111]
    v_mfma_f32_32x32x16_bf16 v[112:127], v[60:63], v[44:47], v[112:127]
    ds_read_b128 v[40:43], v25 offset:0
    ds_read_b128 v[44:47], v25 offset:4096
    ds_read_b64_tr_b16 v[56:57], v20 offset:38912
    ds_read_b64_tr_b16 v[58:59], v20 offset:39936
    ds_read_b64_tr_b16 v[60:61], v21 offset:38912
    ds_read_b64_tr_b16 v[62:63], v21 offset:39936
    s_waitcnt lgkmcnt(6)
    v_mfma_f32_32x32x16_bf16 v[64:79], v[48:51], v[32:35], v[64:79]
    v_mfma_f32_32x32x16_bf16 v[80:95], v[52:55], v[32:35], v[80:95]
    v_mfma_f32_32x32x16_bf16 v[96:111], v[48:51], v[36:39], v[96:111]
    v_mfma_f32_32x32x16_bf16 v[112:127], v[52:55], v[36:39], v[112:127]
    s_waitcnt lgkmcnt(0)
    v_mfma_f32_32x32x16_bf16 v[64:79], v[56:59], v[40:43], v[64:79]
    v_mfma_f32_32x32x16_bf16 v[80:95], v[60:63], v[40:43], v[80:95]
    v_mfma_f32_32x32x16_bf16 v[96:111], v[56:59], v[44:47], v[96:111]
    v_mfma_f32_32x32x16_bf16 v[112:127], v[60:63], v[44:47], v[112:127]
    s_waitcnt vmcnt(6)
    s_barrier
    s_add_u32 m0, s36, 0xc000
    s_nop 0
    buffer_load_dwordx4 v8, s[12:15], s40 offen lds
    s_add_u32 s40, s40, 128
    s_add_u32 m0, s36, 0xe000
    s_nop 0
    buffer_load_dwordx4 v8, s[12:15], s41 offen lds
    s_add_u32 s41, s41, 128
    s_add_u32 m0, s36, 0x10000
    s_nop 0
    buffer_load_dwordx4 v8, s[12:15], s42 offen lds
    s_add_u32 s42, s42, 128
    s_add_u32 m0, s36, 0x12000
    s_nop 0
    buffer_load_dwordx4 v8, s[12:15], s43 offen lds
    s_add_u32 s43, s43, 128
    s_add_u32 m0, s37, 0x14000
    s_nop 0
    buffer_load_dwordx4 v9, s[16:19], s44 offen lds
    s_add_u32 s44, s44, s46
    s_add_u32 m0, s37, 0x14400
    s_nop 0
    buffer_load_dwordx4 v9, s[16:19], s45 offen lds
    s_add_u32 s45, s45, s46
    ds_read_b128 v[32:35], v28 offset:0
    ds_read_b128 v[36:39], v28 offset:4096
    ds_read_b64_tr_b16 v[48:49], v26 offset:32768
    ds_read_b64_tr_b16 v[50:51], v26 offset:33792
    ds_read_b64_tr_b16 v[52:53], v27 offset:32768
    ds_read_b64_tr_b16 v[54:55], v27 offset:33792
    ds_read_b128 v[40:43], v29 offset:0
    ds_read_b128 v[44:47], v29 offset:4096
    ds_read_b64_tr_b16 v[56:57], v26 offset:34816
    ds_read_b64_tr_b16 v[58:59], v26 offset:35840
    ds_read_b64_tr_b16 v[60:61], v27 offset:34816
    ds_read_b64_tr_b16 v[62:63], v27 offset:35840
    s_waitcnt lgkmcnt(6)
    v_mfma_f32_32x32x16_bf16 v[64:79], v[48:51], v[32:35], v[64:79]
    v_mfma_f32_32x32x16_bf16 v[80:95], v[52:55], v[32:35], v[80:95]
    v_mfma_f32_32x32x16_bf16 v[96:111], v[48:51], v[36:39], v[96:111]
    v_mfma_f32_32x32x16_bf16 v[112:127], v[52:55], v[36:39], v[112:127]
    ds_read_b128 v[32:35], v30 offset:0
    ds_read_b128 v[36:39], v30 offset:4096
    ds_read_b64_tr_b16 v[48:49], v26 offset:36864
    ds_read_b64_tr_b16 v[50:51], v26 offset:37888
    ds_read_b64_tr_b16 v[52:53], v27 offset:36864
    ds_read_b64_tr_b16 v[54:55], v27 offset:37888
    s_waitcnt lgkmcnt(6)
    v_mfma_f32_32x32x16_bf16 v[64:79], v[56:59], v[40:43], v[64:79]
    v_mfma_f32_32x32x16_bf16 v[80:95], v[60:63], v[40:43], v[80:95]
    v_mfma_f32_32x32x16_bf16 v[96:111], v[56:59], v[44:47], v[96:111]
    v_mfma_f32_32x32x16_bf16 v[112:127], v[60:63], v[44:47], v[112:127]
    ds_read_b128 v[40:43], v31 offset:0
    ds_read_b128 v[44:47], v31 offset:4096
    ds_read_b64_tr_b16 v[56:57], v26 offset:38912
    ds_read_b64_tr_b16 v[58:59], v26 offset:39936
    ds_read_b64_tr_b16 v[60:61], v27 offset:38912
    ds_read_b64_tr_b16 v[62:63], v27 offset:39936
    s_waitcnt lgkmcnt(6)
    v_mfma_f32_32x32x16_bf16 v[64:79], v[48:51], v[32:35], v[64:79]
    v_mfma_f32_32x32x16_bf16 v[80:95], v[52:55], v[32:35], v[80:95]
    v_mfma_f32_32x32x16_bf16 v[96:111], v[48:51], v[36:39], v[96:111]
    v_mfma_f32_32x32x16_bf16 v[112:127], v[52:55], v[36:39], v[112:127]
    s_waitcnt lgkmcnt(0)
    v_mfma_f32_32x32x16_bf16 v[64:79], v[56:59], v[40:43], v[64:79]
    v_mfma_f32_32x32x16_bf16 v[80:95], v[60:63], v[40:43], v[80:95]
    v_mfma_f32_32x32x16_bf16 v[96:111], v[56:59], v[44:47], v[96:111]
    v_mfma_f32_32x32x16_bf16 v[112:127], v[60:63], v[44:47], v[112:127]
    s_waitcnt vmcnt(6)
    s_barrier
    s_add_u32 m0, s36, 0x18000
    s_nop 0
    buffer_load_dwordx4 v8, s[12:15], s40 offen lds
    s_add_u32 s40, s40, 128
    s_add_u32 m0, s36, 0x1a000
    s_nop 0
    buffer_load_dwordx4 v8, s[12:15], s41 offen lds
    s_add_u32 s41, s41, 128
    s_add_u32 m0, s36, 0x1c000
    s_nop 0
    buffer_load_dwordx4 v8, s[12:15], s42 offen lds
    s_add_u32 s42, s42, 128
    s_add_u32 m0, s36, 0x1e000
    s_nop 0
    buffer_load_dwordx4 v8, s[12:15], s43 offen lds
    s_add_u32 s43, s43, 128
    s_add_u32 m0, s37, 0x20000
    s_nop 0
    buffer_load_dwordx4 v9, s[16:19], s44 offen lds
    s_add_u32 s44, s44, s46
    s_add_u32 m0, s37, 0x20400
    s_nop 0
    buffer_load_dwordx4 v9, s[16:19], s45 offen lds
    s_add_u32 s45, s45, s46
    ds_read_b128 v[32:35], v16 offset:0
    ds_read_b128 v[36:39], v16 offset:4096
    ds_read_b64_tr_b16 v[48:49], v14 offset:32768
    ds_read_b64_tr_b16 v[50:51], v14 offset:33792
    ds_read_b64_tr_b16 v[52:53], v15 offset:32768
    ds_read_b64_tr_b16 v[54:55], v15 offset:33792
    ds_read_b128 v[40:43], v17 offset:0
    ds_read_b128 v[44:47], v17 offset:4096
    ds_read_b64_tr_b16 v[56:57], v14 offset:34816
    ds_read_b64_tr_b16 v[58:59], v14 offset:35840
    ds_read_b64_tr_b16 v[60:61], v15 offset:34816
    ds_read_b64_tr_b16 v[62:63], v15 offset:35840
    s_waitcnt lgkmcnt(6)
    v_mfma_f32_32x32x16_bf16 v[64:79], v[48:51], v[32:35], v[64:79]
    v_mfma_f32_32x32x16_bf16 v[80:95], v[52:55], v[32:35], v[80:95]
    v_mfma_f32_32x32x16_bf16 v[96:111], v[48:51], v[36:39], v[96:111]
    v_mfma_f32_32x32x16_bf16 v[112:127], v[52:55], v[36:39], v[112:127]
    ds_read_b128 v[32:35], v18 offset:0
    ds_read_b128 v[36:39], v18 offset:4096
    ds_read_b64_tr_b16 v[48:49], v14 offset:36864
    ds_read_b64_tr_b16 v[50:51], v14 offset:37888
    ds_read_b64_tr_b16 v[52:53], v15 offset:36864
    ds_read_b64_tr_b16 v[54:55], v15 offset:37888
    s_waitcnt lgkmcnt(6)
    v_mfma_f32_32x32x16_bf16 v[64:79], v[56:59], v[40:43], v[64:79]
    v_mfma_f32_32x32x16_bf16 v[80:95], v[60:63], v[40:43], v[80:95]
    v_mfma_f32_32x32x16_bf16 v[96:111], v[56:59], v[44:47], v[96:111]
    v_mfma_f32_32x32x16_bf16 v[112:127], v[60:63], v[44:47], v[112:127]
    ds_read_b128 v[40:43], v19 offset:0
    ds_read_b128 v[44:47], v19 offset:4096
    ds_read_b64_tr_b16 v[56:57], v14 offset:38912
    ds_read_b64_tr_b16 v[58:59], v14 offset:39936
    ds_read_b64_tr_b16 v[60:61], v15 offset:38912
    ds_read_b64_tr_b16 v[62:63], v15 offset:39936
    s_waitcnt lgkmcnt(6)
    v_mfma_f32_32x32x16_bf16 v[64:79], v[48:51], v[32:35], v[64:79]
    v_mfma_f32_32x32x16_bf16 v[80:95], v[52:55], v[32:35], v[80:95]
    v_mfma_f32_32x32x16_bf16 v[96:111], v[48:51], v[36:39], v[96:111]
    v_mfma_f32_32x32x16_bf16 v[112:127], v[52:55], v[36:39], v[112:127]
    s_waitcnt lgkmcnt(0)
    v_mfma_f32_32x32x16_bf16 v[64:79], v[56:59], v[40:43], v[64:79]
    v_mfma_f32_32x32x16_bf16 v[80:95], v[60:63], v[40:43], v[80:95]
    v_mfma_f32_32x32x16_bf16 v[96:111], v[56:59], v[44:47], v[96:111]
    v_mfma_f32_32x32x16_bf16 v[112:127], v[60:63], v[44:47], v[112:127]
    s_waitcnt vmcnt(6)
    s_barrier
    s_add_u32 m0, s36, 0x0
    s_nop 0
    buffer_load_dwordx4 v8, s[12:15], s40 offen lds
    s_add_u32 s40, s40, 128
    s_add_u32 m0, s36, 0x2000
    s_nop 0
    buffer_load_dwordx4 v8, s[12:15], s41 offen lds
    s_add_u32 s41, s41, 128
    s_add_u32 m0, s36, 0x4000
    s_nop 0
    buffer_load_dwordx4 v8, s[12:15], s42 offen lds
    s_add_u32 s42, s42, 128
    s_add_u32 m0, s36, 0x6000
    s_nop 0
    buffer_load_dwordx4 v8, s[12:15], s43 offen lds
    s_add_u32 s43, s43, 128
    s_add_u32 m0, s37, 0x8000
    s_nop 0
    buffer_load_dwordx4 v9, s[16:19], s44 offen lds
    s_add_u32 s44, s44, s46
    s_add_u32 m0, s37, 0x8400
    s_nop 0
    buffer_load_dwordx4 v9, s[16:19], s45 offen lds
    s_add_u32 s45, s45, s46
    ds_read_b128 v[32:35], v22 offset:0
    ds_read_b128 v[36:39], v22 offset:4096
    ds_read_b64_tr_b16 v[48:49], v20 offset:32768
    ds_read_b64_tr_b16 v[50:51], v20 offset:33792
    ds_read_b64_tr_b16 v[52:53], v21 offset:32768
    ds_read_b64_tr_b16 v[54:55], v21 offset:33792
    ds_read_b128 v[40:43], v23 offset:0
    ds_read_b128 v[44:47], v23 offset:4096
    ds_read_b64_tr_b16 v[56:57], v20 offset:34816
    ds_read_b64_tr_b16 v[58:59], v20 offset:35840
    ds_read_b64_tr_b16 v[60:61], v21 offset:34816
    ds_read_b64_tr_b16 v[62:63], v21 offset:35840
    s_waitcnt lgkmcnt(6)
    v_mfma_f32_32x32x16_bf16 v[64:79], v[48:51], v[32:35], v[64:79]
    v_mfma_f32_32x32x16_bf16 v[80:95], v[52:55], v[32:35], v[80:95]
    v_mfma_f32_32x32x16_bf16 v[96:111], v[48:51], v[36:39], v[96:111]
    v_mfma_f32_32x32x16_bf16 v[112:127], v[52:55], v[36:39], v[112:127]
    ds_read_b128 v[32:35], v24 offset:0
    ds_read_b128 v[36:39], v24 offset:4096
    ds_read_b64_tr_b16 v[48:49], v20 offset:36864
    ds_read_b64_tr_b16 v[50:51], v20 offset:37888
    ds_read_b64_tr_b16 v[52:53], v21 offset:36864
    ds_read_b64_tr_b16 v[54:55], v21 offset:37888
    s_waitcnt lgkmcnt(6)
    v_mfma_f32_32x32x16_bf16 v[64:79], v[56:59], v[40:43], v[64:79]
    v_mfma_f32_32x32x16_bf16 v[80:95], v[60:63], v[40:43], v[80:95]
    v_mfma_f32_32x32x16_bf16 v[96:111], v[56:59], v[44:47], v[96:111]
    v_mfma_f32_32x32x16_bf16 v[112:127], v[60:63], v[44:47], v[112:127]
    ds_read_b128 v[40:43], v25 offset:0
    ds_read_b128 v[44:47], v25 offset:4096
    ds_read_b64_tr_b16 v[56:57], v20 offset:38912
    ds_read_b64_tr_b16 v[58:59], v20 offset:39936
    ds_read_b64_tr_b16 v[60:61], v21 offset:38912
    ds_read_b64_tr_b16 v[62:63], v21 offset:39936
    s_waitcnt lgkmcnt(6)
    v_mfma_f32_32x32x16_bf16 v[64:79], v[48:51], v[32:35], v[64:79]
    v_mfma_f32_32x32x16_bf16 v[80:95], v[52:55], v[32:35], v[80:95]
    v_mfma_f32_32x32x16_bf16 v[96:111], v[48:51], v[36:39], v[96:111]
    v_mfma_f32_32x32x16_bf16 v[112:127], v[52:55], v[36:39], v[112:127]
    s_waitcnt lgkmcnt(0)
    v_mfma_f32_32x32x16_bf16 v[64:79], v[56:59], v[40:43], v[64:79]
    v_mfma_f32_32x32x16_bf16 v[80:95], v[60:63], v[40:43], v[80:95]
    v_mfma_f32_32x32x16_bf16 v[96:111], v[56:59], v[44:47], v[96:111]
    v_mfma_f32_32x32x16_bf16 v[112:127], v[60:63], v[44:47], v[112:127]
    s_waitcnt vmcnt(6)
    s_barrier
    ds_read_b128 v[32:35], v28 offset:0
    ds_read_b128 v[36:39], v28 offset:4096
    ds_read_b64_tr_b16 v[48:49], v26 offset:32768
    ds_read_b64_tr_b16 v[50:51], v26 offset:33792
    ds_read_b64_tr_b16 v[52:53], v27 offset:32768
    ds_read_b64_tr_b16 v[54:55], v27 offset:33792
    ds_read_b128 v[40:43], v29 offset:0
    ds_read_b128 v[44:47], v29 offset:4096
    ds_read_b64_tr_b16 v[56:57], v26 offset:34816
    ds_read_b64_tr_b16 v[58:59], v26 offset:35840
    ds_read_b64_tr_b16 v[60:61], v27 offset:34816
    ds_read_b64_tr_b16 v[62:63], v27 offset:35840
    s_waitcnt lgkmcnt(6)
    v_mfma_f32_32x32x16_bf16 v[64:79], v[48:51], v[32:35], v[64:79]
    v_mfma_f32_32x32x16_bf16 v[80:95], v[52:55], v[32:35], v[80:95]
    v_mfma_f32_32x32x16_bf16 v[96:111], v[48:51], v[36:39], v[96:111]
    v_mfma_f32_32x32x16_bf16 v[112:127], v[52:55], v[36:39], v[112:127]
    ds_read_b128 v[32:35], v30 offset:0
    ds_read_b128 v[36:39], v30 offset:4096
    ds_read_b64_tr_b16 v[48:49], v26 offset:36864
    ds_read_b64_tr_b16 v[50:51], v26 offset:37888
    ds_read_b64_tr_b16 v[52:53], v27 offset:36864
    ds_read_b64_tr_b16 v[54:55], v27 offset:37888
    s_waitcnt lgkmcnt(6)
    v_mfma_f32_32x32x16_bf16 v[64:79], v[56:59], v[40:43], v[64:79]
    v_mfma_f32_32x32x16_bf16 v[80:95], v[60:63], v[40:43], v[80:95]
    v_mfma_f32_32x32x16_bf16 v[96:111], v[56:59], v[44:47], v[96:111]
    v_mfma_f32_32x32x16_bf16 v[112:127], v[60:63], v[44:47], v[112:127]
    ds_read_b128 v[40:43], v31 offset:0
    ds_read_b128 v[44:47], v31 offset:4096
    ds_read_b64_tr_b16 v[56:57], v26 offset:38912
    ds_read_b64_tr_b16 v[58:59], v26 offset:39936
    ds_read_b64_tr_b16 v[60:61], v27 offset:38912
    ds_read_b64_tr_b16 v[62:63], v27 offset:39936
    s_waitcnt lgkmcnt(6)
    v_mfma_f32_32x32x16_bf16 v[64:79], v[48:51], v[32:35], v[64:79]
    v_mfma_f32_32x32x16_bf16 v[80:95], v[52:55], v[32:35], v[80:95]
    v_mfma_f32_32x32x16_bf16 v[96:111], v[48:51], v[36:39], v[96:111]
    v_mfma_f32_32x32x16_bf16 v[112:127], v[52:55], v[36:39], v[112:127]
    s_waitcnt lgkmcnt(0)
    v_mfma_f32_32x32x16_bf16 v[64:79], v[56:59], v[40:43], v[64:79]
    v_mfma_f32_32x32x16_bf16 v[80:95], v[60:63], v[40:43], v[80:95]
    v_mfma_f32_32x32x16_bf16 v[96:111], v[56:59], v[44:47], v[96:111]
    v_mfma_f32_32x32x16_bf16 v[112:127], v[60:63], v[44:47], v[112:127]
    s_waitcnt vmcnt(0)
    s_barrier
    ds_read_b128 v[32:35], v16 offset:0
    ds_read_b128 v[36:39], v16 offset:4096
    ds_read_b64_tr_b16 v[48:49], v14 offset:32768
    ds_read_b64_tr_b16 v[50:51], v14 offset:33792
    ds_read_b64_tr_b16 v[52:53], v15 offset:32768
    ds_read_b64_tr_b16 v[54:55], v15 offset:33792
    ds_read_b128 v[40:43], v17 offset:0
    ds_read_b128 v[44:47], v17 offset:4096
    ds_read_b64_tr_b16 v[56:57], v14 offset:34816
    ds_read_b64_tr_b16 v[58:59], v14 offset:35840
    ds_read_b64_tr_b16 v[60:61], v15 offset:34816
    ds_read_b64_tr_b16 v[62:63], v15 offset:35840
    s_waitcnt lgkmcnt(6)
    v_mfma_f32_32x32x16_bf16 v[64:79], v[48:51], v[32:35], v[64:79]
    v_mfma_f32_32x32x16_bf16 v[80:95], v[52:55], v[32:35], v[80:95]
    v_mfma_f32_32x32x16_bf16 v[96:111], v[48:51], v[36:39], v[96:111]
    v_mfma_f32_32x32x16_bf16 v[112:127], v[52:55], v[36:39], v[112:127]
    ds_read_b128 v[32:35], v18 offset:0
    ds_read_b128 v[36:39], v18 offset:4096
    ds_read_b64_tr_b16 v[48:49], v14 offset:36864
    ds_read_b64_tr_b16 v[50:51], v14 offset:37888
    ds_read_b64_tr_b16 v[52:53], v15 offset:36864
    ds_read_b64_tr_b16 v[54:55], v15 offset:37888
    s_waitcnt lgkmcnt(6)
    v_mfma_f32_32x32x16_bf16 v[64:79], v[56:59], v[40:43], v[64:79]
    v_mfma_f32_32x32x16_bf16 v[80:95], v[60:63], v[40:43], v[80:95]
    v_mfma_f32_32x32x16_bf16 v[96:111], v[56:59], v[44:47], v[96:111]
    v_mfma_f32_32x32x16_bf16 v[112:127], v[60:63], v[44:47], v[112:127]
    ds_read_b128 v[40:43], v19 offset:0
    ds_read_b128 v[44:47], v19 offset:4096
    ds_read_b64_tr_b16 v[56:57], v14 offset:38912
    ds_read_b64_tr_b16 v[58:59], v14 offset:39936
    ds_read_b64_tr_b16 v[60:61], v15 offset:38912
    ds_read_b64_tr_b16 v[62:63], v15 offset:39936
    s_waitcnt lgkmcnt(6)
    v_mfma_f32_32x32x16_bf16 v[64:79], v[48:51], v[32:35], v[64:79]
    v_mfma_f32_32x32x16_bf16 v[80:95], v[52:55], v[32:35], v[80:95]
    v_mfma_f32_32x32x16_bf16 v[96:111], v[48:51], v[36:39], v[96:111]
    v_mfma_f32_32x32x16_bf16 v[112:127], v[52:55], v[36:39], v[112:127]
    s_waitcnt lgkmcnt(0)
    v_mfma_f32_32x32x16_bf16 v[64:79], v[56:59], v[40:43], v[64:79]
    v_mfma_f32_32x32x16_bf16 v[80:95], v[60:63], v[40:43], v[80:95]
    v_mfma_f32_32x32x16_bf16 v[96:111], v[56:59], v[44:47], v[96:111]
    v_mfma_f32_32x32x16_bf16 v[112:127], v[60:63], v[44:47], v[112:127]
    s_nop 15
    s_barrier
    s_cmp_lt_u32 s25, 15
    s_cbranch_scc1 L_g1_norelu_7
    v_max_f32 v64, 0, v64
    v_max_f32 v65, 0, v65
    v_max_f32 v66, 0, v66
    v_max_f32 v67, 0, v67
    v_max_f32 v68, 0, v68
    v_max_f32 v69, 0, v69
    v_max_f32 v70, 0, v70
    v_max_f32 v71, 0, v71
    v_max_f32 v72, 0, v72
    v_max_f32 v73, 0, v73
    v_max_f32 v74, 0, v74
    v_max_f32 v75, 0, v75
    v_max_f32 v76, 0, v76
    v_max_f32 v77, 0, v77
    v_max_f32 v78, 0, v78
    v_max_f32 v79, 0, v79
    v_max_f32 v80, 0, v80
    v_max_f32 v81, 0, v81
    v_max_f32 v82, 0, v82
    v_max_f32 v83, 0, v83
    v_max_f32 v84, 0, v84
    v_max_f32 v85, 0, v85
    v_max_f32 v86, 0, v86
    v_max_f32 v87, 0, v87
    v_max_f32 v88, 0, v88
    v_max_f32 v89, 0, v89
    v_max_f32 v90, 0, v90
    v_max_f32 v91, 0, v91
    v_max_f32 v92, 0, v92
    v_max_f32 v93, 0, v93
    v_max_f32 v94, 0, v94
    v_max_f32 v95, 0, v95
    v_max_f32 v96, 0, v96
    v_max_f32 v97, 0, v97
    v_max_f32 v98, 0, v98
    v_max_f32 v99, 0, v99
    v_max_f32 v100, 0, v100
    v_max_f32 v101, 0, v101
    v_max_f32 v102, 0, v102
    v_max_f32 v103, 0, v103
    v_max_f32 v104, 0, v104
    v_max_f32 v105, 0, v105
    v_max_f32 v106, 0, v106
    v_max_f32 v107, 0, v107
    v_max_f32 v108, 0, v108
    v_max_f32 v109, 0, v109
    v_max_f32 v110, 0, v110
    v_max_f32 v111, 0, v111
    v_max_f32 v112, 0, v112
    v_max_f32 v113, 0, v113
    v_max_f32 v114, 0, v114
    v_max_f32 v115, 0, v115
    v_max_f32 v116, 0, v116
    v_max_f32 v117, 0, v117
    v_max_f32 v118, 0, v118
    v_max_f32 v119, 0, v119
    v_max_f32 v120, 0, v120
    v_max_f32 v121, 0, v121
    v_max_f32 v122, 0, v122
    v_max_f32 v123, 0, v123
    v_max_f32 v124, 0, v124
    v_max_f32 v125, 0, v125
    v_max_f32 v126, 0, v126
    v_max_f32 v127, 0, v127
L_g1_norelu_7:
    v_add_u32 v20, s32, v3
    v_mul_u32_u24 v20, 264, v20
    v_lshl_add_u32 v20, v4, 3, v20
    s_lshl_b32 s41, s30, 7
    v_add_u32 v20, s41, v20
    v_cvt_pk_bf16_f32 v64, v64, v65
    v_cvt_pk_bf16_f32 v65, v66, v67
    ds_write_b64 v20, v[64:65] offset:0
    v_cvt_pk_bf16_f32 v68, v68, v69
    v_cvt_pk_bf16_f32 v69, v70, v71
    ds_write_b64 v20, v[68:69] offset:16
    v_cvt_pk_bf16_f32 v72, v72, v73
    v_cvt_pk_bf16_f32 v73, v74, v75
    ds_write_b64 v20, v[72:73] offset:32
    v_cvt_pk_bf16_f32 v76, v76, v77
    v_cvt_pk_bf16_f32 v77, v78, v79
    ds_write_b64 v20, v[76:77] offset:48
    v_cvt_pk_bf16_f32 v80, v80, v81
    v_cvt_pk_bf16_f32 v81, v82, v83
    ds_write_b64 v20, v[80:81] offset:64
    v_cvt_pk_bf16_f32 v84, v84, v85
    v_cvt_pk_bf16_f32 v85, v86, v87
    ds_write_b64 v20, v[84:85] offset:80
    v_cvt_pk_bf16_f32 v88, v88, v89
    v_cvt_pk_bf16_f32 v89, v90, v91
    ds_write_b64 v20, v[88:89] offset:96
    v_cvt_pk_bf16_f32 v92, v92, v93
    v_cvt_pk_bf16_f32 v93, v94, v95
    ds_write_b64 v20, v[92:93] offset:112
    v_cvt_pk_bf16_f32 v96, v96, v97
    v_cvt_pk_bf16_f32 v97, v98, v99
    ds_write_b64 v20, v[96:97] offset:8448
    v_cvt_pk_bf16_f32 v100, v100, v101
    v_cvt_pk_bf16_f32 v101, v102, v103
    ds_write_b64 v20, v[100:101] offset:8464
    v_cvt_pk_bf16_f32 v104, v104, v105
    v_cvt_pk_bf16_f32 v105, v106, v107
    ds_write_b64 v20, v[104:105] offset:8480
    v_cvt_pk_bf16_f32 v108, v108, v109
    v_cvt_pk_bf16_f32 v109, v110, v111
    ds_write_b64 v20, v[108:109] offset:8496
    v_cvt_pk_bf16_f32 v112, v112, v113
    v_cvt_pk_bf16_f32 v113, v114, v115
    ds_write_b64 v20, v[112:113] offset:8512
    v_cvt_pk_bf16_f32 v116, v116, v117
    v_cvt_pk_bf16_f32 v117, v118, v119
    ds_write_b64 v20, v[116:117] offset:8528
    v_cvt_pk_bf16_f32 v120, v120, v121
    v_cvt_pk_bf16_f32 v121, v122, v123
    ds_write_b64 v20, v[120:121] offset:8544
    v_cvt_pk_bf16_f32 v124, v124, v125
    v_cvt_pk_bf16_f32 v125, v126, v127
    ds_write_b64 v20, v[124:125] offset:8560
    s_waitcnt lgkmcnt(0)
    s_barrier
    v_and_b32 v21, 31, v0
    v_lshrrev_b32 v22, 5, v0
    v_mul_u32_u24 v23, 264, v22
    v_lshl_add_u32 v23, v21, 3, v23
    ds_read_b64 v[64:65], v23 offset:0
    ds_read_b64 v[66:67], v23 offset:4224
    ds_read_b64 v[68:69], v23 offset:8448
    ds_read_b64 v[70:71], v23 offset:12672
    ds_read_b64 v[72:73], v23 offset:16896
    ds_read_b64 v[74:75], v23 offset:21120
    ds_read_b64 v[76:77], v23 offset:25344
    ds_read_b64 v[78:79], v23 offset:29568
    ds_read_b64 v[80:81], v23 offset:33792
    ds_read_b64 v[82:83], v23 offset:38016
    ds_read_b64 v[84:85], v23 offset:42240
    ds_read_b64 v[86:87], v23 offset:46464
    ds_read_b64 v[88:89], v23 offset:50688
    ds_read_b64 v[90:91], v23 offset:54912
    ds_read_b64 v[92:93], v23 offset:59136
    ds_read_b64 v[94:95], v23 offset:63360
    s_cmp_ge_u32 s25, 15
    s_cbranch_scc1 L_g1_h_8
    s_add_u32 s20, s8, 0x400000
    s_addc_u32 s21, s9, 0
    s_and_b32 s21, s21, 0xffff
    s_mov_b32 s22, 0x500000
    s_mov_b32 s23, 0x20000
    s_lshl_b32 s39, s25, 7
    v_lshl_add_u32 v24, v21, 2, s39
    v_mul_u32_u24 v25, 0xcccd, v24
    v_lshrrev_b32 v25, 20, v25
    v_mul_u32_u24 v26, 20, v25
    v_sub_u32 v26, v24, v26
    s_mov_b32 s40, 81920
    v_mul_lo_u32 v25, v25, s40
    v_lshl_add_u32 v25, v26, 1, v25
    s_lshl_b32 s41, s24, 8
    v_add_u32 v26, s41, v22
    v_mul_u32_u24 v26, 40, v26
    v_add_u32 v25, v25, v26
    s_waitcnt lgkmcnt(0)
    buffer_store_dwordx2 v[64:65], v25, s[20:23], 0 offen offset:0
    buffer_store_dwordx2 v[66:67], v25, s[20:23], 0 offen offset:640
    buffer_store_dwordx2 v[68:69], v25, s[20:23], 0 offen offset:1280
    buffer_store_dwordx2 v[70:71], v25, s[20:23], 0 offen offset:1920
    v_add_u32 v25, 2560, v25
    buffer_store_dwordx2 v[72:73], v25, s[20:23], 0 offen offset:0
    buffer_store_dwordx2 v[74:75], v25, s[20:23], 0 offen offset:640
    buffer_store_dwordx2 v[76:77], v25, s[20:23], 0 offen offset:1280
    buffer_store_dwordx2 v[78:79], v25, s[20:23], 0 offen offset:1920
    v_add_u32 v25, 2560, v25
    buffer_store_dwordx2 v[80:81], v25, s[20:23], 0 offen offset:0
    buffer_store_dwordx2 v[82:83], v25, s[20:23], 0 offen offset:640
    buffer_store_dwordx2 v[84:85], v25, s[20:23], 0 offen offset:1280
    buffer_store_dwordx2 v[86:87], v25, s[20:23], 0 offen offset:1920
    v_add_u32 v25, 2560, v25
    buffer_store_dwordx2 v[88:89], v25, s[20:23], 0 offen offset:0
    buffer_store_dwordx2 v[90:91], v25, s[20:23], 0 offen offset:640
    buffer_store_dwordx2 v[92:93], v25, s[20:23], 0 offen offset:1280
    buffer_store_dwordx2 v[94:95], v25, s[20:23], 0 offen offset:1920
    v_add_u32 v25, 2560, v25
    s_endpgm
L_g1_h_8:
    s_add_u32 s20, s8, 0x1000000
    s_addc_u32 s21, s9, 0
    s_and_b32 s21, s21, 0xffff
    s_mov_b32 s22, 0x600000
    s_mov_b32 s23, 0x20000
    s_sub_u32 s39, s25, 15
    s_lshl_b32 s39, s39, 8
    s_lshl_b32 s41, s24, 8
    v_add_u32 v26, s41, v22
    v_mul_u32_u24 v26, 3072, v26
    v_lshl_add_u32 v26, v21, 3, v26
    v_add_u32 v26, s39, v26
    s_mov_b32 s40, 0
    s_waitcnt lgkmcnt(0)
    buffer_store_dwordx2 v[64:65], v26, s[20:23], s40 offen
    s_add_u32 s40, s40, 49152
    buffer_store_dwordx2 v[66:67], v26, s[20:23], s40 offen
    s_add_u32 s40, s40, 49152
    buffer_store_dwordx2 v[68:69], v26, s[20:23], s40 offen
    s_add_u32 s40, s40, 49152
    buffer_store_dwordx2 v[70:71], v26, s[20:23], s40 offen
    s_add_u32 s40, s40, 49152
    buffer_store_dwordx2 v[72:73], v26, s[20:23], s40 offen
    s_add_u32 s40, s40, 49152
    buffer_store_dwordx2 v[74:75], v26, s[20:23], s40 offen
    s_add_u32 s40, s40, 49152
    buffer_store_dwordx2 v[76:77], v26, s[20:23], s40 offen
    s_add_u32 s40, s40, 49152
    buffer_store_dwordx2 v[78:79], v26, s[20:23], s40 offen
    s_add_u32 s40, s40, 49152
    buffer_store_dwordx2 v[80:81], v26, s[20:23], s40 offen
    s_add_u32 s40, s40, 49152
    buffer_store_dwordx2 v[82:83], v26, s[20:23], s40 offen
    s_add_u32 s40, s40, 49152
    buffer_store_dwordx2 v[84:85], v26, s[20:23], s40 offen
    s_add_u32 s40, s40, 49152
    buffer_store_dwordx2 v[86:87], v26, s[20:23], s40 offen
    s_add_u32 s40, s40, 49152
    buffer_store_dwordx2 v[88:89], v26, s[20:23], s40 offen
    s_add_u32 s40, s40, 49152
    buffer_store_dwordx2 v[90:91], v26, s[20:23], s40 offen
    s_add_u32 s40, s40, 49152
    buffer_store_dwordx2 v[92:93], v26, s[20:23], s40 offen
    s_add_u32 s40, s40, 49152
    buffer_store_dwordx2 v[94:95], v26, s[20:23], s40 offen
    s_add_u32 s40, s40, 49152
    s_endpgm
L_g1_v_5:
    v_add_u32 v22, 0xc000, v16
    v_add_u32 v23, 0xc000, v17
    v_add_u32 v24, 0xc000, v18
    v_add_u32 v25, 0xc000, v19
    v_add_u32 v20, 0xc000, v14
    v_add_u32 v21, 0xc000, v15
    v_add_u32 v28, 0x18000, v16
    v_add_u32 v29, 0x18000, v17
    v_add_u32 v30, 0x18000, v18
    v_add_u32 v31, 0x18000, v19
    v_add_u32 v26, 0x18000, v14
    v_add_u32 v27, 0x18000, v15
    s_add_u32 m0, s36, 0x0
    s_nop 0
    buffer_load_dwordx4 v8, s[12:15], s40 offen lds
    s_add_u32 s40, s40, 128
    s_add_u32 m0, s36, 0x2000
    s_nop 0
    buffer_load_dwordx4 v8, s[12:15], s41 offen lds
    s_add_u32 s41, s41, 128
    s_add_u32 m0, s36, 0x4000
    s_nop 0
    buffer_load_dwordx4 v8, s[12:15], s42 offen lds
    s_add_u32 s42, s42, 128
    s_add_u32 m0, s36, 0x6000
    s_nop 0
    buffer_load_dwordx4 v8, s[12:15], s43 offen lds
    s_add_u32 s43, s43, 128
    s_add_u32 m0, s37, 0x8000
    s_nop 0
    buffer_load_dwordx4 v9, s[16:19], s44 offen lds
    s_add_u32 s44, s44, s46
    s_add_u32 m0, s37, 0x8400
    s_nop 0
    buffer_load_dwordx4 v9, s[16:19], s45 offen lds
    s_add_u32 s45, s45, s46
    s_add_u32 m0, s36, 0xc000
    s_nop 0
    buffer_load_dwordx4 v8, s[12:15], s40 offen lds
    s_add_u32 s40, s40, 128
    s_add_u32 m0, s36, 0xe000
    s_nop 0
    buffer_load_dwordx4 v8, s[12:15], s41 offen lds
    s_add_u32 s41, s41, 128
    s_add_u32 m0, s36, 0x10000
    s_nop 0
    buffer_load_dwordx4 v8, s[12:15], s42 offen lds
    s_add_u32 s42, s42, 128
    s_add_u32 m0, s36, 0x12000
    s_nop 0
    buffer_load_dwordx4 v8, s[12:15], s43 offen lds
    s_add_u32 s43, s43, 128
    s_add_u32 m0, s37, 0x14000
    s_nop 0
    buffer_load_dwordx4 v9, s[16:19], s44 offen lds
    s_add_u32 s44, s44, s46
    s_add_u32 m0, s37, 0x14400
    s_nop 0
    buffer_load_dwordx4 v9, s[16:19], s45 offen lds
    s_add_u32 s45, s45, s46
    s_waitcnt vmcnt(6)
    s_barrier
    s_add_u32 m0, s36, 0x18000
    s_nop 0
    buffer_load_dwordx4 v8, s[12:15], s40 offen lds
    s_add_u32 s40, s40, 128
    s_add_u32 m0, s36, 0x1a000
    s_nop 0
    buffer_load_dwordx4 v8, s[12:15], s41 offen lds
    s_add_u32 s41, s41, 128
    s_add_u32 m0, s36, 0x1c000
    s_nop 0
    buffer_load_dwordx4 v8, s[12:15], s42 offen lds
    s_add_u32 s42, s42, 128
    s_add_u32 m0, s36, 0x1e000
    s_nop 0
    buffer_load_dwordx4 v8, s[12:15], s43 offen lds
    s_add_u32 s43, s43, 128
    s_add_u32 m0, s37, 0x20000
    s_nop 0
    buffer_load_dwordx4 v9, s[16:19], s44 offen lds
    s_add_u32 s44, s44, s46
    s_add_u32 m0, s37, 0x20400
    s_nop 0
    buffer_load_dwordx4 v9, s[16:19], s45 offen lds
    s_add_u32 s45, s45, s46
    ds_read_b128 v[32:35], v16 offset:0
    ds_read_b128 v[36:39], v16 offset:4096
    ds_read_b64_tr_b16 v[48:49], v14 offset:32768
    ds_read_b64_tr_b16 v[50:51], v14 offset:33792
    ds_read_b64_tr_b16 v[52:53], v15 offset:32768
    ds_read_b64_tr_b16 v[54:55], v15 offset:33792
    ds_read_b128 v[40:43], v17 offset:0
    ds_read_b128 v[44:47], v17 offset:4096
    ds_read_b64_tr_b16 v[56:57], v14 offset:34816
    ds_read_b64_tr_b16 v[58:59], v14 offset:35840
    ds_read_b64_tr_b16 v[60:61], v15 offset:34816
    ds_read_b64_tr_b16 v[62:63], v15 offset:35840
    s_waitcnt lgkmcnt(6)
    v_mfma_f32_32x32x16_bf16 v[64:79], v[32:35], v[48:51], 0
    v_mfma_f32_32x32x16_bf16 v[80:95], v[32:35], v[52:55], 0
    v_mfma_f32_32x32x16_bf16 v[96:111], v[36:39], v[48:51], 0
    v_mfma_f32_32x32x16_bf16 v[112:127], v[36:39], v[52:55], 0
    ds_read_b128 v[32:35], v18 offset:0
    ds_read_b128 v[36:39], v18 offset:4096
    ds_read_b64_tr_b16 v[48:49], v14 offset:36864
    ds_read_b64_tr_b16 v[50:51], v14 offset:37888
    ds_read_b64_tr_b16 v[52:53], v15 offset:36864
    ds_read_b64_tr_b16 v[54:55], v15 offset:37888
    s_waitcnt lgkmcnt(6)
    v_mfma_f32_32x32x16_bf16 v[64:79], v[40:43], v[56:59], v[64:79]
    v_mfma_f32_32x32x16_bf16 v[80:95], v[40:43], v[60:63], v[80:95]
    v_mfma_f32_32x32x16_bf16 v[96:111], v[44:47], v[56:59], v[96:111]
    v_mfma_f32_32x32x16_bf16 v[112:127], v[44:47], v[60:63], v[112:127]
    ds_read_b128 v[40:43], v19 offset:0
    ds_read_b128 v[44:47], v19 offset:4096
    ds_read_b64_tr_b16 v[56:57], v14 offset:38912
    ds_read_b64_tr_b16 v[58:59], v14 offset:39936
    ds_read_b64_tr_b16 v[60:61], v15 offset:38912
    ds_read_b64_tr_b16 v[62:63], v15 offset:39936
    s_waitcnt lgkmcnt(6)
    v_mfma_f32_32x32x16_bf16 v[64:79], v[32:35], v[48:51], v[64:79]
    v_mfma_f32_32x32x16_bf16 v[80:95], v[32:35], v[52:55], v[80:95]
    v_mfma_f32_32x32x16_bf16 v[96:111], v[36:39], v[48:51], v[96:111]
    v_mfma_f32_32x32x16_bf16 v[112:127], v[36:39], v[52:55], v[112:127]
    s_waitcnt lgkmcnt(0)
    v_mfma_f32_32x32x16_bf16 v[64:79], v[40:43], v[56:59], v[64:79]
    v_mfma_f32_32x32x16_bf16 v[80:95], v[40:43], v[60:63], v[80:95]
    v_mfma_f32_32x32x16_bf16 v[96:111], v[44:47], v[56:59], v[96:111]
    v_mfma_f32_32x32x16_bf16 v[112:127], v[44:47], v[60:63], v[112:127]
    s_waitcnt vmcnt(6)
    s_barrier
    s_add_u32 m0, s36, 0x0
    s_nop 0
    buffer_load_dwordx4 v8, s[12:15], s40 offen lds
    s_add_u32 s40, s40, 128
    s_add_u32 m0, s36, 0x2000
    s_nop 0
    buffer_load_dwordx4 v8, s[12:15], s41 offen lds
    s_add_u32 s41, s41, 128
    s_add_u32 m0, s36, 0x4000
    s_nop 0
    buffer_load_dwordx4 v8, s[12:15], s42 offen lds
    s_add_u32 s42, s42, 128
    s_add_u32 m0, s36, 0x6000
    s_nop 0
    buffer_load_dwordx4 v8, s[12:15], s43 offen lds
    s_add_u32 s43, s43, 128
    s_add_u32 m0, s37, 0x8000
    s_nop 0
    buffer_load_dwordx4 v9, s[16:19], s44 offen lds
    s_add_u32 s44, s44, s46
    s_add_u32 m0, s37, 0x8400
    s_nop 0
    buffer_load_dwordx4 v9, s[16:19], s45 offen lds
    s_add_u32 s45, s45, s46
    ds_read_b128 v[32:35], v22 offset:0
    ds_read_b128 v[36:39], v22 offset:4096
    ds_read_b64_tr_b16 v[48:49], v20 offset:32768
    ds_read_b64_tr_b16 v[50:51], v20 offset:33792
    ds_read_b64_tr_b16 v[52:53], v21 offset:32768
    ds_read_b64_tr_b16 v[54:55], v21 offset:33792
    ds_read_b128 v[40:43], v23 offset:0
    ds_read_b128 v[44:47], v23 offset:4096
    ds_read_b64_tr_b16 v[56:57], v20 offset:34816
    ds_read_b64_tr_b16 v[58:59], v20 offset:35840
    ds_read_b64_tr_b16 v[60:61], v21 offset:34816
    ds_read_b64_tr_b16 v[62:63], v21 offset:35840
    s_waitcnt lgkmcnt(6)
    v_mfma_f32_32x32x16_bf16 v[64:79], v[32:35], v[48:51], v[64:79]
    v_mfma_f32_32x32x16_bf16 v[80:95], v[32:35], v[52:55], v[80:95]
    v_mfma_f32_32x32x16_bf16 v[96:111], v[36:39], v[48:51], v[96:111]
    v_mfma_f32_32x32x16_bf16 v[112:127], v[36:39], v[52:55], v[112:127]
    ds_read_b128 v[32:35], v24 offset:0
    ds_read_b128 v[36:39], v24 offset:4096
    ds_read_b64_tr_b16 v[48:49], v20 offset:36864
    ds_read_b64_tr_b16 v[50:51], v20 offset:37888
    ds_read_b64_tr_b16 v[52:53], v21 offset:36864
    ds_read_b64_tr_b16 v[54:55], v21 offset:37888
    s_waitcnt lgkmcnt(6)
    v_mfma_f32_32x32x16_bf16 v[64:79], v[40:43], v[56:59], v[64:79]
    v_mfma_f32_32x32x16_bf16 v[80:95], v[40:43], v[60:63], v[80:95]
    v_mfma_f32_32x32x16_bf16 v[96:111], v[44:47], v[56:59], v[96:111]
    v_mfma_f32_32x32x16_bf16 v[112:127], v[44:47], v[60:63], v[112:127]
    ds_read_b128 v[40:43], v25 offset:0
    ds_read_b128 v[44:47], v25 offset:4096
    ds_read_b64_tr_b16 v[56:57], v20 offset:38912
    ds_read_b64_tr_b16 v[58:59], v20 offset:39936
    ds_read_b64_tr_b16 v[60:61], v21 offset:38912
    ds_read_b64_tr_b16 v[62:63], v21 offset:39936
    s_waitcnt lgkmcnt(6)
    v_mfma_f32_32x32x16_bf16 v[64:79], v[32:35], v[48:51], v[64:79]
    v_mfma_f32_32x32x16_bf16 v[80:95], v[32:35], v[52:55], v[80:95]
    v_mfma_f32_32x32x16_bf16 v[96:111], v[36:39], v[48:51], v[96:111]
    v_mfma_f32_32x32x16_bf16 v[112:127], v[36:39], v[52:55], v[112:127]
    s_waitcnt lgkmcnt(0)
    v_mfma_f32_32x32x16_bf16 v[64:79], v[40:43], v[56:59], v[64:79]
    v_mfma_f32_32x32x16_bf16 v[80:95], v[40:43], v[60:63], v[80:95]
    v_mfma_f32_32x32x16_bf16 v[96:111], v[44:47], v[56:59], v[96:111]
    v_mfma_f32_32x32x16_bf16 v[112:127], v[44:47], v[60:63], v[112:127]
    s_waitcnt vmcnt(6)
    s_barrier
    s_add_u32 m0, s36, 0xc000
    s_nop 0
    buffer_load_dwordx4 v8, s[12:15], s40 offen lds
    s_add_u32 s40, s40, 128
    s_add_u32 m0, s36, 0xe000
    s_nop 0
    buffer_load_dwordx4 v8, s[12:15], s41 offen lds
    s_add_u32 s41, s41, 128
    s_add_u32 m0, s36, 0x10000
    s_nop 0
    buffer_load_dwordx4 v8, s[12:15], s42 offen lds
    s_add_u32 s42, s42, 128
    s_add_u32 m0, s36, 0x12000
    s_nop 0
    buffer_load_dwordx4 v8, s[12:15], s43 offen lds
    s_add_u32 s43, s43, 128
    s_add_u32 m0, s37, 0x14000
    s_nop 0
    buffer_load_dwordx4 v9, s[16:19], s44 offen lds
    s_add_u32 s44, s44, s46
    s_add_u32 m0, s37, 0x14400
    s_nop 0
    buffer_load_dwordx4 v9, s[16:19], s45 offen lds
    s_add_u32 s45, s45, s46
    ds_read_b128 v[32:35], v28 offset:0
    ds_read_b128 v[36:39], v28 offset:4096
    ds_read_b64_tr_b16 v[48:49], v26 offset:32768
    ds_read_b64_tr_b16 v[50:51], v26 offset:33792
    ds_read_b64_tr_b16 v[52:53], v27 offset:32768
    ds_read_b64_tr_b16 v[54:55], v27 offset:33792
    ds_read_b128 v[40:43], v29 offset:0
    ds_read_b128 v[44:47], v29 offset:4096
    ds_read_b64_tr_b16 v[56:57], v26 offset:34816
    ds_read_b64_tr_b16 v[58:59], v26 offset:35840
    ds_read_b64_tr_b16 v[60:61], v27 offset:34816
    ds_read_b64_tr_b16 v[62:63], v27 offset:35840
    s_waitcnt lgkmcnt(6)
    v_mfma_f32_32x32x16_bf16 v[64:79], v[32:35], v[48:51], v[64:79]
    v_mfma_f32_32x32x16_bf16 v[80:95], v[32:35], v[52:55], v[80:95]
    v_mfma_f32_32x32x16_bf16 v[96:111], v[36:39], v[48:51], v[96:111]
    v_mfma_f32_32x32x16_bf16 v[112:127], v[36:39], v[52:55], v[112:127]
    ds_read_b128 v[32:35], v30 offset:0
    ds_read_b128 v[36:39], v30 offset:4096
    ds_read_b64_tr_b16 v[48:49], v26 offset:36864
    ds_read_b64_tr_b16 v[50:51], v26 offset:37888
    ds_read_b64_tr_b16 v[52:53], v27 offset:36864
    ds_read_b64_tr_b16 v[54:55], v27 offset:37888
    s_waitcnt lgkmcnt(6)
    v_mfma_f32_32x32x16_bf16 v[64:79], v[40:43], v[56:59], v[64:79]
    v_mfma_f32_32x32x16_bf16 v[80:95], v[40:43], v[60:63], v[80:95]
    v_mfma_f32_32x32x16_bf16 v[96:111], v[44:47], v[56:59], v[96:111]
    v_mfma_f32_32x32x16_bf16 v[112:127], v[44:47], v[60:63], v[112:127]
    ds_read_b128 v[40:43], v31 offset:0
    ds_read_b128 v[44:47], v31 offset:4096
    ds_read_b64_tr_b16 v[56:57], v26 offset:38912
    ds_read_b64_tr_b16 v[58:59], v26 offset:39936
    ds_read_b64_tr_b16 v[60:61], v27 offset:38912
    ds_read_b64_tr_b16 v[62:63], v27 offset:39936
    s_waitcnt lgkmcnt(6)
    v_mfma_f32_32x32x16_bf16 v[64:79], v[32:35], v[48:51], v[64:79]
    v_mfma_f32_32x32x16_bf16 v[80:95], v[32:35], v[52:55], v[80:95]
    v_mfma_f32_32x32x16_bf16 v[96:111], v[36:39], v[48:51], v[96:111]
    v_mfma_f32_32x32x16_bf16 v[112:127], v[36:39], v[52:55], v[112:127]
    s_waitcnt lgkmcnt(0)
    v_mfma_f32_32x32x16_bf16 v[64:79], v[40:43], v[56:59], v[64:79]
    v_mfma_f32_32x32x16_bf16 v[80:95], v[40:43], v[60:63], v[80:95]
    v_mfma_f32_32x32x16_bf16 v[96:111], v[44:47], v[56:59], v[96:111]
    v_mfma_f32_32x32x16_bf16 v[112:127], v[44:47], v[60:63], v[112:127]
    s_waitcnt vmcnt(6)
    s_barrier
    s_add_u32 m0, s36, 0x18000
    s_nop 0
    buffer_load_dwordx4 v8, s[12:15], s40 offen lds
    s_add_u32 s40, s40, 128
    s_add_u32 m0, s36, 0x1a000
    s_nop 0
    buffer_load_dwordx4 v8, s[12:15], s41 offen lds
    s_add_u32 s41, s41, 128
    s_add_u32 m0, s36, 0x1c000
    s_nop 0
    buffer_load_dwordx4 v8, s[12:15], s42 offen lds
    s_add_u32 s42, s42, 128
    s_add_u32 m0, s36, 0x1e000
    s_nop 0
    buffer_load_dwordx4 v8, s[12:15], s43 offen lds
    s_add_u32 s43, s43, 128
    s_add_u32 m0, s37, 0x20000
    s_nop 0
    buffer_load_dwordx4 v9, s[16:19], s44 offen lds
    s_add_u32 s44, s44, s46
    s_add_u32 m0, s37, 0x20400
    s_nop 0
    buffer_load_dwordx4 v9, s[16:19], s45 offen lds
    s_add_u32 s45, s45, s46
    ds_read_b128 v[32:35], v16 offset:0
    ds_read_b128 v[36:39], v16 offset:4096
    ds_read_b64_tr_b16 v[48:49], v14 offset:32768
    ds_read_b64_tr_b16 v[50:51], v14 offset:33792
    ds_read_b64_tr_b16 v[52:53], v15 offset:32768
    ds_read_b64_tr_b16 v[54:55], v15 offset:33792
    ds_read_b128 v[40:43], v17 offset:0
    ds_read_b128 v[44:47], v17 offset:4096
    ds_read_b64_tr_b16 v[56:57], v14 offset:34816
    ds_read_b64_tr_b16 v[58:59], v14 offset:35840
    ds_read_b64_tr_b16 v[60:61], v15 offset:34816
    ds_read_b64_tr_b16 v[62:63], v15 offset:35840
    s_waitcnt lgkmcnt(6)
    v_mfma_f32_32x32x16_bf16 v[64:79], v[32:35], v[48:51], v[64:79]
    v_mfma_f32_32x32x16_bf16 v[80:95], v[32:35], v[52:55], v[80:95]
    v_mfma_f32_32x32x16_bf16 v[96:111], v[36:39], v[48:51], v[96:111]
    v_mfma_f32_32x32x16_bf16 v[112:127], v[36:39], v[52:55], v[112:127]
    ds_read_b128 v[32:35], v18 offset:0
    ds_read_b128 v[36:39], v18 offset:4096
    ds_read_b64_tr_b16 v[48:49], v14 offset:36864
    ds_read_b64_tr_b16 v[50:51], v14 offset:37888
    ds_read_b64_tr_b16 v[52:53], v15 offset:36864
    ds_read_b64_tr_b16 v[54:55], v15 offset:37888
    s_waitcnt lgkmcnt(6)
    v_mfma_f32_32x32x16_bf16 v[64:79], v[40:43], v[56:59], v[64:79]
    v_mfma_f32_32x32x16_bf16 v[80:95], v[40:43], v[60:63], v[80:95]
    v_mfma_f32_32x32x16_bf16 v[96:111], v[44:47], v[56:59], v[96:111]
    v_mfma_f32_32x32x16_bf16 v[112:127], v[44:47], v[60:63], v[112:127]
    ds_read_b128 v[40:43], v19 offset:0
    ds_read_b128 v[44:47], v19 offset:4096
    ds_read_b64_tr_b16 v[56:57], v14 offset:38912
    ds_read_b64_tr_b16 v[58:59], v14 offset:39936
    ds_read_b64_tr_b16 v[60:61], v15 offset:38912
    ds_read_b64_tr_b16 v[62:63], v15 offset:39936
    s_waitcnt lgkmcnt(6)
    v_mfma_f32_32x32x16_bf16 v[64:79], v[32:35], v[48:51], v[64:79]
    v_mfma_f32_32x32x16_bf16 v[80:95], v[32:35], v[52:55], v[80:95]
    v_mfma_f32_32x32x16_bf16 v[96:111], v[36:39], v[48:51], v[96:111]
    v_mfma_f32_32x32x16_bf16 v[112:127], v[36:39], v[52:55], v[112:127]
    s_waitcnt lgkmcnt(0)
    v_mfma_f32_32x32x16_bf16 v[64:79], v[40:43], v[56:59], v[64:79]
    v_mfma_f32_32x32x16_bf16 v[80:95], v[40:43], v[60:63], v[80:95]
    v_mfma_f32_32x32x16_bf16 v[96:111], v[44:47], v[56:59], v[96:111]
    v_mfma_f32_32x32x16_bf16 v[112:127], v[44:47], v[60:63], v[112:127]
    s_waitcnt vmcnt(6)
    s_barrier
    s_add_u32 m0, s36, 0x0
    s_nop 0
    buffer_load_dwordx4 v8, s[12:15], s40 offen lds
    s_add_u32 s40, s40, 128
    s_add_u32 m0, s36, 0x2000
    s_nop 0
    buffer_load_dwordx4 v8, s[12:15], s41 offen lds
    s_add_u32 s41, s41, 128
    s_add_u32 m0, s36, 0x4000
    s_nop 0
    buffer_load_dwordx4 v8, s[12:15], s42 offen lds
    s_add_u32 s42, s42, 128
    s_add_u32 m0, s36, 0x6000
    s_nop 0
    buffer_load_dwordx4 v8, s[12:15], s43 offen lds
    s_add_u32 s43, s43, 128
    s_add_u32 m0, s37, 0x8000
    s_nop 0
    buffer_load_dwordx4 v9, s[16:19], s44 offen lds
    s_add_u32 s44, s44, s46
    s_add_u32 m0, s37, 0x8400
    s_nop 0
    buffer_load_dwordx4 v9, s[16:19], s45 offen lds
    s_add_u32 s45, s45, s46
    ds_read_b128 v[32:35], v22 offset:0
    ds_read_b128 v[36:39], v22 offset:4096
    ds_read_b64_tr_b16 v[48:49], v20 offset:32768
    ds_read_b64_tr_b16 v[50:51], v20 offset:33792
    ds_read_b64_tr_b16 v[52:53], v21 offset:32768
    ds_read_b64_tr_b16 v[54:55], v21 offset:33792
    ds_read_b128 v[40:43], v23 offset:0
    ds_read_b128 v[44:47], v23 offset:4096
    ds_read_b64_tr_b16 v[56:57], v20 offset:34816
    ds_read_b64_tr_b16 v[58:59], v20 offset:35840
    ds_read_b64_tr_b16 v[60:61], v21 offset:34816
    ds_read_b64_tr_b16 v[62:63], v21 offset:35840
    s_waitcnt lgkmcnt(6)
    v_mfma_f32_32x32x16_bf16 v[64:79], v[32:35], v[48:51], v[64:79]
    v_mfma_f32_32x32x16_bf16 v[80:95], v[32:35], v[52:55], v[80:95]
    v_mfma_f32_32x32x16_bf16 v[96:111], v[36:39], v[48:51], v[96:111]
    v_mfma_f32_32x32x16_bf16 v[112:127], v[36:39], v[52:55], v[112:127]
    ds_read_b128 v[32:35], v24 offset:0
    ds_read_b128 v[36:39], v24 offset:4096
    ds_read_b64_tr_b16 v[48:49], v20 offset:36864
    ds_read_b64_tr_b16 v[50:51], v20 offset:37888
    ds_read_b64_tr_b16 v[52:53], v21 offset:36864
    ds_read_b64_tr_b16 v[54:55], v21 offset:37888
    s_waitcnt lgkmcnt(6)
    v_mfma_f32_32x32x16_bf16 v[64:79], v[40:43], v[56:59], v[64:79]
    v_mfma_f32_32x32x16_bf16 v[80:95], v[40:43], v[60:63], v[80:95]
    v_mfma_f32_32x32x16_bf16 v[96:111], v[44:47], v[56:59], v[96:111]
    v_mfma_f32_32x32x16_bf16 v[112:127], v[44:47], v[60:63], v[112:127]
    ds_read_b128 v[40:43], v25 offset:0
    ds_read_b128 v[44:47], v25 offset:4096
    ds_read_b64_tr_b16 v[56:57], v20 offset:38912
    ds_read_b64_tr_b16 v[58:59], v20 offset:39936
    ds_read_b64_tr_b16 v[60:61], v21 offset:38912
    ds_read_b64_tr_b16 v[62:63], v21 offset:39936
    s_waitcnt lgkmcnt(6)
    v_mfma_f32_32x32x16_bf16 v[64:79], v[32:35], v[48:51], v[64:79]
    v_mfma_f32_32x32x16_bf16 v[80:95], v[32:35], v[52:55], v[80:95]
    v_mfma_f32_32x32x16_bf16 v[96:111], v[36:39], v[48:51], v[96:111]
    v_mfma_f32_32x32x16_bf16 v[112:127], v[36:39], v[52:55], v[112:127]
    s_waitcnt lgkmcnt(0)
    v_mfma_f32_32x32x16_bf16 v[64:79], v[40:43], v[56:59], v[64:79]
    v_mfma_f32_32x32x16_bf16 v[80:95], v[40:43], v[60:63], v[80:95]
    v_mfma_f32_32x32x16_bf16 v[96:111], v[44:47], v[56:59], v[96:111]
    v_mfma_f32_32x32x16_bf16 v[112:127], v[44:47], v[60:63], v[112:127]
    s_waitcnt vmcnt(6)
    s_barrier
    s_add_u32 m0, s36, 0xc000
    s_nop 0
    buffer_load_dwordx4 v8, s[12:15], s40 offen lds
    s_add_u32 s40, s40, 128
    s_add_u32 m0, s36, 0xe000
    s_nop 0
    buffer_load_dwordx4 v8, s[12:15], s41 offen lds
    s_add_u32 s41, s41, 128
    s_add_u32 m0, s36, 0x10000
    s_nop 0
    buffer_load_dwordx4 v8, s[12:15], s42 offen lds
    s_add_u32 s42, s42, 128
    s_add_u32 m0, s36, 0x12000
    s_nop 0
    buffer_load_dwordx4 v8, s[12:15], s43 offen lds
    s_add_u32 s43, s43, 128
    s_add_u32 m0, s37, 0x14000
    s_nop 0
    buffer_load_dwordx4 v9, s[16:19], s44 offen lds
    s_add_u32 s44, s44, s46
    s_add_u32 m0, s37, 0x14400
    s_nop 0
    buffer_load_dwordx4 v9, s[16:19], s45 offen lds
    s_add_u32 s45, s45, s46
    ds_read_b128 v[32:35], v28 offset:0
    ds_read_b128 v[36:39], v28 offset:4096
    ds_read_b64_tr_b16 v[48:49], v26 offset:32768
    ds_read_b64_tr_b16 v[50:51], v26 offset:33792
    ds_read_b64_tr_b16 v[52:53], v27 offset:32768
    ds_read_b64_tr_b16 v[54:55], v27 offset:33792
    ds_read_b128 v[40:43], v29 offset:0
    ds_read_b128 v[44:47], v29 offset:4096
    ds_read_b64_tr_b16 v[56:57], v26 offset:34816
    ds_read_b64_tr_b16 v[58:59], v26 offset:35840
    ds_read_b64_tr_b16 v[60:61], v27 offset:34816
    ds_read_b64_tr_b16 v[62:63], v27 offset:35840
    s_waitcnt lgkmcnt(6)
    v_mfma_f32_32x32x16_bf16 v[64:79], v[32:35], v[48:51], v[64:79]
    v_mfma_f32_32x32x16_bf16 v[80:95], v[32:35], v[52:55], v[80:95]
    v_mfma_f32_32x32x16_bf16 v[96:111], v[36:39], v[48:51], v[96:111]
    v_mfma_f32_32x32x16_bf16 v[112:127], v[36:39], v[52:55], v[112:127]
    ds_read_b128 v[32:35], v30 offset:0
    ds_read_b128 v[36:39], v30 offset:4096
    ds_read_b64_tr_b16 v[48:49], v26 offset:36864
    ds_read_b64_tr_b16 v[50:51], v26 offset:37888
    ds_read_b64_tr_b16 v[52:53], v27 offset:36864
    ds_read_b64_tr_b16 v[54:55], v27 offset:37888
    s_waitcnt lgkmcnt(6)
    v_mfma_f32_32x32x16_bf16 v[64:79], v[40:43], v[56:59], v[64:79]
    v_mfma_f32_32x32x16_bf16 v[80:95], v[40:43], v[60:63], v[80:95]
    v_mfma_f32_32x32x16_bf16 v[96:111], v[44:47], v[56:59], v[96:111]
    v_mfma_f32_32x32x16_bf16 v[112:127], v[44:47], v[60:63], v[112:127]
    ds_read_b128 v[40:43], v31 offset:0
    ds_read_b128 v[44:47], v31 offset:4096
    ds_read_b64_tr_b16 v[56:57], v26 offset:38912
    ds_read_b64_tr_b16 v[58:59], v26 offset:39936
    ds_read_b64_tr_b16 v[60:61], v27 offset:38912
    ds_read_b64_tr_b16 v[62:63], v27 offset:39936
    s_waitcnt lgkmcnt(6)
    v_mfma_f32_32x32x16_bf16 v[64:79], v[32:35], v[48:51], v[64:79]
    v_mfma_f32_32x32x16_bf16 v[80:95], v[32:35], v[52:55], v[80:95]
    v_mfma_f32_32x32x16_bf16 v[96:111], v[36:39], v[48:51], v[96:111]
    v_mfma_f32_32x32x16_bf16 v[112:127], v[36:39], v[52:55], v[112:127]
    s_waitcnt lgkmcnt(0)
    v_mfma_f32_32x32x16_bf16 v[64:79], v[40:43], v[56:59], v[64:79]
    v_mfma_f32_32x32x16_bf16 v[80:95], v[40:43], v[60:63], v[80:95]
    v_mfma_f32_32x32x16_bf16 v[96:111], v[44:47], v[56:59], v[96:111]
    v_mfma_f32_32x32x16_bf16 v[112:127], v[44:47], v[60:63], v[112:127]
    s_waitcnt vmcnt(6)
    s_barrier
    s_add_u32 m0, s36, 0x18000
    s_nop 0
    buffer_load_dwordx4 v8, s[12:15], s40 offen lds
    s_add_u32 s40, s40, 128
    s_add_u32 m0, s36, 0x1a000
    s_nop 0
    buffer_load_dwordx4 v8, s[12:15], s41 offen lds
    s_add_u32 s41, s41, 128
    s_add_u32 m0, s36, 0x1c000
    s_nop 0
    buffer_load_dwordx4 v8, s[12:15], s42 offen lds
    s_add_u32 s42, s42, 128
    s_add_u32 m0, s36, 0x1e000
    s_nop 0
    buffer_load_dwordx4 v8, s[12:15], s43 offen lds
    s_add_u32 s43, s43, 128
    s_add_u32 m0, s37, 0x20000
    s_nop 0
    buffer_load_dwordx4 v9, s[16:19], s44 offen lds
    s_add_u32 s44, s44, s46
    s_add_u32 m0, s37, 0x20400
    s_nop 0
    buffer_load_dwordx4 v9, s[16:19], s45 offen lds
    s_add_u32 s45, s45, s46
    ds_read_b128 v[32:35], v16 offset:0
    ds_read_b128 v[36:39], v16 offset:4096
    ds_read_b64_tr_b16 v[48:49], v14 offset:32768
    ds_read_b64_tr_b16 v[50:51], v14 offset:33792
    ds_read_b64_tr_b16 v[52:53], v15 offset:32768
    ds_read_b64_tr_b16 v[54:55], v15 offset:33792
    ds_read_b128 v[40:43], v17 offset:0
    ds_read_b128 v[44:47], v17 offset:4096
    ds_read_b64_tr_b16 v[56:57], v14 offset:34816
    ds_read_b64_tr_b16 v[58:59], v14 offset:35840
    ds_read_b64_tr_b16 v[60:61], v15 offset:34816
    ds_read_b64_tr_b16 v[62:63], v15 offset:35840
    s_waitcnt lgkmcnt(6)
    v_mfma_f32_32x32x16_bf16 v[64:79], v[32:35], v[48:51], v[64:79]
    v_mfma_f32_32x32x16_bf16 v[80:95], v[32:35], v[52:55], v[80:95]
    v_mfma_f32_32x32x16_bf16 v[96:111], v[36:39], v[48:51], v[96:111]
    v_mfma_f32_32x32x16_bf16 v[112:127], v[36:39], v[52:55], v[112:127]
    ds_read_b128 v[32:35], v18 offset:0
    ds_read_b128 v[36:39], v18 offset:4096
    ds_read_b64_tr_b16 v[48:49], v14 offset:36864
    ds_read_b64_tr_b16 v[50:51], v14 offset:37888
    ds_read_b64_tr_b16 v[52:53], v15 offset:36864
    ds_read_b64_tr_b16 v[54:55], v15 offset:37888
    s_waitcnt lgkmcnt(6)
    v_mfma_f32_32x32x16_bf16 v[64:79], v[40:43], v[56:59], v[64:79]
    v_mfma_f32_32x32x16_bf16 v[80:95], v[40:43], v[60:63], v[80:95]
    v_mfma_f32_32x32x16_bf16 v[96:111], v[44:47], v[56:59], v[96:111]
    v_mfma_f32_32x32x16_bf16 v[112:127], v[44:47], v[60:63], v[112:127]
    ds_read_b128 v[40:43], v19 offset:0
    ds_read_b128 v[44:47], v19 offset:4096
    ds_read_b64_tr_b16 v[56:57], v14 offset:38912
    ds_read_b64_tr_b16 v[58:59], v14 offset:39936
    ds_read_b64_tr_b16 v[60:61], v15 offset:38912
    ds_read_b64_tr_b16 v[62:63], v15 offset:39936
    s_waitcnt lgkmcnt(6)
    v_mfma_f32_32x32x16_bf16 v[64:79], v[32:35], v[48:51], v[64:79]
    v_mfma_f32_32x32x16_bf16 v[80:95], v[32:35], v[52:55], v[80:95]
    v_mfma_f32_32x32x16_bf16 v[96:111], v[36:39], v[48:51], v[96:111]
    v_mfma_f32_32x32x16_bf16 v[112:127], v[36:39], v[52:55], v[112:127]
    s_waitcnt lgkmcnt(0)
    v_mfma_f32_32x32x16_bf16 v[64:79], v[40:43], v[56:59], v[64:79]
    v_mfma_f32_32x32x16_bf16 v[80:95], v[40:43], v[60:63], v[80:95]
    v_mfma_f32_32x32x16_bf16 v[96:111], v[44:47], v[56:59], v[96:111]
    v_mfma_f32_32x32x16_bf16 v[112:127], v[44:47], v[60:63], v[112:127]
    s_waitcnt vmcnt(6)
    s_barrier
    s_add_u32 m0, s36, 0x0
    s_nop 0
    buffer_load_dwordx4 v8, s[12:15], s40 offen lds
    s_add_u32 s40, s40, 128
    s_add_u32 m0, s36, 0x2000
    s_nop 0
    buffer_load_dwordx4 v8, s[12:15], s41 offen lds
    s_add_u32 s41, s41, 128
    s_add_u32 m0, s36, 0x4000
    s_nop 0
    buffer_load_dwordx4 v8, s[12:15], s42 offen lds
    s_add_u32 s42, s42, 128
    s_add_u32 m0, s36, 0x6000
    s_nop 0
    buffer_load_dwordx4 v8, s[12:15], s43 offen lds
    s_add_u32 s43, s43, 128
    s_add_u32 m0, s37, 0x8000
    s_nop 0
    buffer_load_dwordx4 v9, s[16:19], s44 offen lds
    s_add_u32 s44, s44, s46
    s_add_u32 m0, s37, 0x8400
    s_nop 0
    buffer_load_dwordx4 v9, s[16:19], s45 offen lds
    s_add_u32 s45, s45, s46
    ds_read_b128 v[32:35], v22 offset:0
    ds_read_b128 v[36:39], v22 offset:4096
    ds_read_b64_tr_b16 v[48:49], v20 offset:32768
    ds_read_b64_tr_b16 v[50:51], v20 offset:33792
    ds_read_b64_tr_b16 v[52:53], v21 offset:32768
    ds_read_b64_tr_b16 v[54:55], v21 offset:33792
    ds_read_b128 v[40:43], v23 offset:0
    ds_read_b128 v[44:47], v23 offset:4096
    ds_read_b64_tr_b16 v[56:57], v20 offset:34816
    ds_read_b64_tr_b16 v[58:59], v20 offset:35840
    ds_read_b64_tr_b16 v[60:61], v21 offset:34816
    ds_read_b64_tr_b16 v[62:63], v21 offset:35840
    s_waitcnt lgkmcnt(6)
    v_mfma_f32_32x32x16_bf16 v[64:79], v[32:35], v[48:51], v[64:79]
    v_mfma_f32_32x32x16_bf16 v[80:95], v[32:35], v[52:55], v[80:95]
    v_mfma_f32_32x32x16_bf16 v[96:111], v[36:39], v[48:51], v[96:111]
    v_mfma_f32_32x32x16_bf16 v[112:127], v[36:39], v[52:55], v[112:127]
    ds_read_b128 v[32:35], v24 offset:0
    ds_read_b128 v[36:39], v24 offset:4096
    ds_read_b64_tr_b16 v[48:49], v20 offset:36864
    ds_read_b64_tr_b16 v[50:51], v20 offset:37888
    ds_read_b64_tr_b16 v[52:53], v21 offset:36864
    ds_read_b64_tr_b16 v[54:55], v21 offset:37888
    s_waitcnt lgkmcnt(6)
    v_mfma_f32_32x32x16_bf16 v[64:79], v[40:43], v[56:59], v[64:79]
    v_mfma_f32_32x32x16_bf16 v[80:95], v[40:43], v[60:63], v[80:95]
    v_mfma_f32_32x32x16_bf16 v[96:111], v[44:47], v[56:59], v[96:111]
    v_mfma_f32_32x32x16_bf16 v[112:127], v[44:47], v[60:63], v[112:127]
    ds_read_b128 v[40:43], v25 offset:0
    ds_read_b128 v[44:47], v25 offset:4096
    ds_read_b64_tr_b16 v[56:57], v20 offset:38912
    ds_read_b64_tr_b16 v[58:59], v20 offset:39936
    ds_read_b64_tr_b16 v[60:61], v21 offset:38912
    ds_read_b64_tr_b16 v[62:63], v21 offset:39936
    s_waitcnt lgkmcnt(6)
    v_mfma_f32_32x32x16_bf16 v[64:79], v[32:35], v[48:51], v[64:79]
    v_mfma_f32_32x32x16_bf16 v[80:95], v[32:35], v[52:55], v[80:95]
    v_mfma_f32_32x32x16_bf16 v[96:111], v[36:39], v[48:51], v[96:111]
    v_mfma_f32_32x32x16_bf16 v[112:127], v[36:39], v[52:55], v[112:127]
    s_waitcnt lgkmcnt(0)
    v_mfma_f32_32x32x16_bf16 v[64:79], v[40:43], v[56:59], v[64:79]
    v_mfma_f32_32x32x16_bf16 v[80:95], v[40:43], v[60:63], v[80:95]
    v_mfma_f32_32x32x16_bf16 v[96:111], v[44:47], v[56:59], v[96:111]
    v_mfma_f32_32x32x16_bf16 v[112:127], v[44:47], v[60:63], v[112:127]
    s_waitcnt vmcnt(6)
    s_barrier
    ds_read_b128 v[32:35], v28 offset:0
    ds_read_b128 v[36:39], v28 offset:4096
    ds_read_b64_tr_b16 v[48:49], v26 offset:32768
    ds_read_b64_tr_b16 v[50:51], v26 offset:33792
    ds_read_b64_tr_b16 v[52:53], v27 offset:32768
    ds_read_b64_tr_b16 v[54:55], v27 offset:33792
    ds_read_b128 v[40:43], v29 offset:0
    ds_read_b128 v[44:47], v29 offset:4096
    ds_read_b64_tr_b16 v[56:57], v26 offset:34816
    ds_read_b64_tr_b16 v[58:59], v26 offset:35840
    ds_read_b64_tr_b16 v[60:61], v27 offset:34816
    ds_read_b64_tr_b16 v[62:63], v27 offset:35840
    s_waitcnt lgkmcnt(6)
    v_mfma_f32_32x32x16_bf16 v[64:79], v[32:35], v[48:51], v[64:79]
    v_mfma_f32_32x32x16_bf16 v[80:95], v[32:35], v[52:55], v[80:95]
    v_mfma_f32_32x32x16_bf16 v[96:111], v[36:39], v[48:51], v[96:111]
    v_mfma_f32_32x32x16_bf16 v[112:127], v[36:39], v[52:55], v[112:127]
    ds_read_b128 v[32:35], v30 offset:0
    ds_read_b128 v[36:39], v30 offset:4096
    ds_read_b64_tr_b16 v[48:49], v26 offset:36864
    ds_read_b64_tr_b16 v[50:51], v26 offset:37888
    ds_read_b64_tr_b16 v[52:53], v27 offset:36864
    ds_read_b64_tr_b16 v[54:55], v27 offset:37888
    s_waitcnt lgkmcnt(6)
    v_mfma_f32_32x32x16_bf16 v[64:79], v[40:43], v[56:59], v[64:79]
    v_mfma_f32_32x32x16_bf16 v[80:95], v[40:43], v[60:63], v[80:95]
    v_mfma_f32_32x32x16_bf16 v[96:111], v[44:47], v[56:59], v[96:111]
    v_mfma_f32_32x32x16_bf16 v[112:127], v[44:47], v[60:63], v[112:127]
    ds_read_b128 v[40:43], v31 offset:0
    ds_read_b128 v[44:47], v31 offset:4096
    ds_read_b64_tr_b16 v[56:57], v26 offset:38912
    ds_read_b64_tr_b16 v[58:59], v26 offset:39936
    ds_read_b64_tr_b16 v[60:61], v27 offset:38912
    ds_read_b64_tr_b16 v[62:63], v27 offset:39936
    s_waitcnt lgkmcnt(6)
    v_mfma_f32_32x32x16_bf16 v[64:79], v[32:35], v[48:51], v[64:79]
    v_mfma_f32_32x32x16_bf16 v[80:95], v[32:35], v[52:55], v[80:95]
    v_mfma_f32_32x32x16_bf16 v[96:111], v[36:39], v[48:51], v[96:111]
    v_mfma_f32_32x32x16_bf16 v[112:127], v[36:39], v[52:55], v[112:127]
    s_waitcnt lgkmcnt(0)
    v_mfma_f32_32x32x16_bf16 v[64:79], v[40:43], v[56:59], v[64:79]
    v_mfma_f32_32x32x16_bf16 v[80:95], v[40:43], v[60:63], v[80:95]
    v_mfma_f32_32x32x16_bf16 v[96:111], v[44:47], v[56:59], v[96:111]
    v_mfma_f32_32x32x16_bf16 v[112:127], v[44:47], v[60:63], v[112:127]
    s_waitcnt vmcnt(0)
    s_barrier
    ds_read_b128 v[32:35], v16 offset:0
    ds_read_b128 v[36:39], v16 offset:4096
    ds_read_b64_tr_b16 v[48:49], v14 offset:32768
    ds_read_b64_tr_b16 v[50:51], v14 offset:33792
    ds_read_b64_tr_b16 v[52:53], v15 offset:32768
    ds_read_b64_tr_b16 v[54:55], v15 offset:33792
    ds_read_b128 v[40:43], v17 offset:0
    ds_read_b128 v[44:47], v17 offset:4096
    ds_read_b64_tr_b16 v[56:57], v14 offset:34816
    ds_read_b64_tr_b16 v[58:59], v14 offset:35840
    ds_read_b64_tr_b16 v[60:61], v15 offset:34816
    ds_read_b64_tr_b16 v[62:63], v15 offset:35840
    s_waitcnt lgkmcnt(6)
    v_mfma_f32_32x32x16_bf16 v[64:79], v[32:35], v[48:51], v[64:79]
    v_mfma_f32_32x32x16_bf16 v[80:95], v[32:35], v[52:55], v[80:95]
    v_mfma_f32_32x32x16_bf16 v[96:111], v[36:39], v[48:51], v[96:111]
    v_mfma_f32_32x32x16_bf16 v[112:127], v[36:39], v[52:55], v[112:127]
    ds_read_b128 v[32:35], v18 offset:0
    ds_read_b128 v[36:39], v18 offset:4096
    ds_read_b64_tr_b16 v[48:49], v14 offset:36864
    ds_read_b64_tr_b16 v[50:51], v14 offset:37888
    ds_read_b64_tr_b16 v[52:53], v15 offset:36864
    ds_read_b64_tr_b16 v[54:55], v15 offset:37888
    s_waitcnt lgkmcnt(6)
    v_mfma_f32_32x32x16_bf16 v[64:79], v[40:43], v[56:59], v[64:79]
    v_mfma_f32_32x32x16_bf16 v[80:95], v[40:43], v[60:63], v[80:95]
    v_mfma_f32_32x32x16_bf16 v[96:111], v[44:47], v[56:59], v[96:111]
    v_mfma_f32_32x32x16_bf16 v[112:127], v[44:47], v[60:63], v[112:127]
    ds_read_b128 v[40:43], v19 offset:0
    ds_read_b128 v[44:47], v19 offset:4096
    ds_read_b64_tr_b16 v[56:57], v14 offset:38912
    ds_read_b64_tr_b16 v[58:59], v14 offset:39936
    ds_read_b64_tr_b16 v[60:61], v15 offset:38912
    ds_read_b64_tr_b16 v[62:63], v15 offset:39936
    s_waitcnt lgkmcnt(6)
    v_mfma_f32_32x32x16_bf16 v[64:79], v[32:35], v[48:51], v[64:79]
    v_mfma_f32_32x32x16_bf16 v[80:95], v[32:35], v[52:55], v[80:95]
    v_mfma_f32_32x32x16_bf16 v[96:111], v[36:39], v[48:51], v[96:111]
    v_mfma_f32_32x32x16_bf16 v[112:127], v[36:39], v[52:55], v[112:127]
    s_waitcnt lgkmcnt(0)
    v_mfma_f32_32x32x16_bf16 v[64:79], v[40:43], v[56:59], v[64:79]
    v_mfma_f32_32x32x16_bf16 v[80:95], v[40:43], v[60:63], v[80:95]
    v_mfma_f32_32x32x16_bf16 v[96:111], v[44:47], v[56:59], v[96:111]
    v_mfma_f32_32x32x16_bf16 v[112:127], v[44:47], v[60:63], v[112:127]
    s_nop 15
    s_barrier
    s_lshl_b32 s41, s30, 6
    v_add_u32 v20, s41, v3
    v_mul_u32_u24 v20, 520, v20
    v_lshl_add_u32 v20, v4, 3, v20
    s_lshl_b32 s41, s29, 7
    v_add_u32 v20, s41, v20
    v_cvt_pk_bf16_f32 v64, v64, v65
    v_cvt_pk_bf16_f32 v65, v66, v67
    ds_write_b64 v20, v[64:65] offset:0
    v_cvt_pk_bf16_f32 v68, v68, v69
    v_cvt_pk_bf16_f32 v69, v70, v71
    ds_write_b64 v20, v[68:69] offset:16
    v_cvt_pk_bf16_f32 v72, v72, v73
    v_cvt_pk_bf16_f32 v73, v74, v75
    ds_write_b64 v20, v[72:73] offset:32
    v_cvt_pk_bf16_f32 v76, v76, v77
    v_cvt_pk_bf16_f32 v77, v78, v79
    ds_write_b64 v20, v[76:77] offset:48
    v_cvt_pk_bf16_f32 v80, v80, v81
    v_cvt_pk_bf16_f32 v81, v82, v83
    ds_write_b64 v20, v[80:81] offset:16640
    v_cvt_pk_bf16_f32 v84, v84, v85
    v_cvt_pk_bf16_f32 v85, v86, v87
    ds_write_b64 v20, v[84:85] offset:16656
    v_cvt_pk_bf16_f32 v88, v88, v89
    v_cvt_pk_bf16_f32 v89, v90, v91
    ds_write_b64 v20, v[88:89] offset:16672
    v_cvt_pk_bf16_f32 v92, v92, v93
    v_cvt_pk_bf16_f32 v93, v94, v95
    ds_write_b64 v20, v[92:93] offset:16688
    v_cvt_pk_bf16_f32 v96, v96, v97
    v_cvt_pk_bf16_f32 v97, v98, v99
    ds_write_b64 v20, v[96:97] offset:64
    v_cvt_pk_bf16_f32 v100, v100, v101
    v_cvt_pk_bf16_f32 v101, v102, v103
    ds_write_b64 v20, v[100:101] offset:80
    v_cvt_pk_bf16_f32 v104, v104, v105
    v_cvt_pk_bf16_f32 v105, v106, v107
    ds_write_b64 v20, v[104:105] offset:96
    v_cvt_pk_bf16_f32 v108, v108, v109
    v_cvt_pk_bf16_f32 v109, v110, v111
    ds_write_b64 v20, v[108:109] offset:112
    v_cvt_pk_bf16_f32 v112, v112, v113
    v_cvt_pk_bf16_f32 v113, v114, v115
    ds_write_b64 v20, v[112:113] offset:16704
    v_cvt_pk_bf16_f32 v116, v116, v117
    v_cvt_pk_bf16_f32 v117, v118, v119
    ds_write_b64 v20, v[116:117] offset:16720
    v_cvt_pk_bf16_f32 v120, v120, v121
    v_cvt_pk_bf16_f32 v121, v122, v123
    ds_write_b64 v20, v[120:121] offset:16736
    v_cvt_pk_bf16_f32 v124, v124, v125
    v_cvt_pk_bf16_f32 v125, v126, v127
    ds_write_b64 v20, v[124:125] offset:16752
    s_waitcnt lgkmcnt(0)
    s_barrier
    v_and_b32 v21, 63, v0
    v_lshrrev_b32 v22, 6, v0
    v_mul_u32_u24 v23, 520, v22
    v_lshl_add_u32 v23, v21, 3, v23
    ds_read_b64 v[64:65], v23 offset:0
    ds_read_b64 v[66:67], v23 offset:4160
    ds_read_b64 v[68:69], v23 offset:8320
    ds_read_b64 v[70:71], v23 offset:12480
    ds_read_b64 v[72:73], v23 offset:16640
    ds_read_b64 v[74:75], v23 offset:20800
    ds_read_b64 v[76:77], v23 offset:24960
    ds_read_b64 v[78:79], v23 offset:29120
    ds_read_b64 v[80:81], v23 offset:33280
    ds_read_b64 v[82:83], v23 offset:37440
    ds_read_b64 v[84:85], v23 offset:41600
    ds_read_b64 v[86:87], v23 offset:45760
    ds_read_b64 v[88:89], v23 offset:49920
    ds_read_b64 v[90:91], v23 offset:54080
    ds_read_b64 v[92:93], v23 offset:58240
    ds_read_b64 v[94:95], v23 offset:62400
    s_add_u32 s20, s8, 0xa00000
    s_addc_u32 s21, s9, 0
    s_and_b32 s21, s21, 0xffff
    s_mov_b32 s22, 0x280000
    s_mov_b32 s23, 0x20000
    s_sub_u32 s38, s25, 10
    s_lshl_b32 s38, s38, 7
    v_add_u32 v26, s38, v22
    v_lshlrev_b32 v26, 12, v26
    v_lshl_add_u32 v26, v21, 3, v26
    s_lshl_b32 s39, s24, 9
    v_add_u32 v26, s39, v26
    s_mov_b32 s40, 0
    s_waitcnt lgkmcnt(0)
    buffer_store_dwordx2 v[64:65], v26, s[20:23], s40 offen
    s_add_u32 s40, s40, 32768
    buffer_store_dwordx2 v[66:67], v26, s[20:23], s40 offen
    s_add_u32 s40, s40, 32768
    buffer_store_dwordx2 v[68:69], v26, s[20:23], s40 offen
    s_add_u32 s40, s40, 32768
    buffer_store_dwordx2 v[70:71], v26, s[20:23], s40 offen
    s_add_u32 s40, s40, 32768
    buffer_store_dwordx2 v[72:73], v26, s[20:23], s40 offen
    s_add_u32 s40, s40, 32768
    buffer_store_dwordx2 v[74:75], v26, s[20:23], s40 offen
    s_add_u32 s40, s40, 32768
    buffer_store_dwordx2 v[76:77], v26, s[20:23], s40 offen
    s_add_u32 s40, s40, 32768
    buffer_store_dwordx2 v[78:79], v26, s[20:23], s40 offen
    s_add_u32 s40, s40, 32768
    buffer_store_dwordx2 v[80:81], v26, s[20:23], s40 offen
    s_add_u32 s40, s40, 32768
    buffer_store_dwordx2 v[82:83], v26, s[20:23], s40 offen
    s_add_u32 s40, s40, 32768
    buffer_store_dwordx2 v[84:85], v26, s[20:23], s40 offen
    s_add_u32 s40, s40, 32768
    buffer_store_dwordx2 v[86:87], v26, s[20:23], s40 offen
    s_add_u32 s40, s40, 32768
    buffer_store_dwordx2 v[88:89], v26, s[20:23], s40 offen
    s_add_u32 s40, s40, 32768
    buffer_store_dwordx2 v[90:91], v26, s[20:23], s40 offen
    s_add_u32 s40, s40, 32768
    buffer_store_dwordx2 v[92:93], v26, s[20:23], s40 offen
    s_add_u32 s40, s40, 32768
    buffer_store_dwordx2 v[94:95], v26, s[20:23], s40 offen
    s_add_u32 s40, s40, 32768
L_g1_end_2:
    s_endpgm
.globl attn_kernel
.p2align 8
.type attn_kernel,@function
attn_kernel:
    s_cmp_ge_u32 s2, 512
    s_cbranch_scc1 L_at_end_9
    s_load_dwordx2 s[8:9], s[0:1], 64
    v_lshrrev_b32 v1, 6, v0
    s_nop 0
    v_readfirstlane_b32 s26, v1
    v_and_b32 v2, 63, v0
    s_lshr_b32 s24, s2, 4
    s_and_b32 s25, s2, 15
    s_waitcnt lgkmcnt(0)
    s_add_u32 s12, s8, 0x400000
    s_addc_u32 s13, s9, 0
    s_and_b32 s13, s13, 0xffff
    s_mov_b32 s14, 0x500000
    s_mov_b32 s15, 0x20000
    s_add_u32 s16, s8, 0xa00000
    s_addc_u32 s17, s9, 0
    s_and_b32 s17, s17, 0xffff
    s_mov_b32 s18, 0x280000
    s_mov_b32 s19, 0x20000
    s_add_u32 s20, s8, 0x1800000
    s_addc_u32 s21, s9, 0
    s_and_b32 s21, s21, 0xffff
    s_mov_b32 s22, 0x280000
    s_mov_b32 s23, 0x20000
    v_and_b32 v3, 31, v2
    v_lshrrev_b32 v4, 5, v2
    v_lshlrev_b32 v5, 4, v2
    s_lshl_b32 s27, s25, 7
    s_mul_i32 s28, s24, 81920
    s_mul_i32 s29, s27, 40
    s_add_u32 s30, s28, s29
    s_add_u32 s31, s30, 2611200
    s_lshl_b32 s33, s26, 10
    s_add_u32 s33, s33, 0
    s_mov_b32 m0, s33
    s_add_u32 s34, s33, s31
    buffer_load_dwordx4 v5, s[12:15], s34 offen lds
L_at_kd_10:
    s_lshl_b32 s33, s26, 10
    s_add_u32 s33, s33, 4096
    s_mov_b32 m0, s33
    s_add_u32 s34, s33, s31
    buffer_load_dwordx4 v5, s[12:15], s34 offen lds
L_at_kd_11:
    s_lshl_b32 s33, s26, 10
    s_add_u32 s33, s33, 8192
    s_mov_b32 m0, s33
    s_add_u32 s34, s33, s31
    buffer_load_dwordx4 v5, s[12:15], s34 offen lds
L_at_kd_12:
    s_cmp_ge_u32 s26, 3
    s_cbranch_scc1 L_at_kd_13
    s_lshl_b32 s33, s26, 10
    s_add_u32 s33, s33, 12288
    s_mov_b32 m0, s33
    s_add_u32 s34, s33, s31
    buffer_load_dwordx4 v5, s[12:15], s34 offen lds
L_at_kd_13:
    s_lshl_b32 s33, s26, 10
    s_add_u32 m0, s33, 15360
    s_add_u32 s34, s33, s30
    buffer_load_dwordx4 v5, s[12:15], s34 offen lds
    s_cmp_lg_u32 s26, 0
    s_cbranch_scc1 L_at_qd_14
    s_mov_b32 m0, 19456
    s_add_u32 s34, s30, 4096
    buffer_load_dwordx4 v5, s[12:15], s34 offen lds
L_at_qd_14:
    s_mul_i32 s35, s24, 20
    s_lshl_b32 s36, s27, 1
    s_sub_u32 s36, s36, 512
    s_lshl_b32 s33, s26, 10
    s_add_u32 s33, s33, 0
    v_add_u32 v6, s33, v5
    v_mul_u32_u24 v7, 43691, v6
    v_lshrrev_b32 v7, 25, v7
    v_mul_u32_u24 v8, 768, v7
    v_sub_u32 v8, v6, v8
    v_add_u32 v7, s35, v7
    v_lshl_add_u32 v8, v7, 12, v8
    v_add_u32 v8, s36, v8
    s_add_u32 m0, s33, 20480
    s_nop 0
    buffer_load_dwordx4 v8, s[16:19], 0 offen lds
L_at_vd_15:
    s_lshl_b32 s33, s26, 10
    s_add_u32 s33, s33, 4096
    v_add_u32 v6, s33, v5
    v_mul_u32_u24 v7, 43691, v6
    v_lshrrev_b32 v7, 25, v7
    v_mul_u32_u24 v8, 768, v7
    v_sub_u32 v8, v6, v8
    v_add_u32 v7, s35, v7
    v_lshl_add_u32 v8, v7, 12, v8
    v_add_u32 v8, s36, v8
    s_add_u32 m0, s33, 20480
    s_nop 0
    buffer_load_dwordx4 v8, s[16:19], 0 offen lds
L_at_vd_16:
    s_lshl_b32 s33, s26, 10
    s_add_u32 s33, s33, 8192
    v_add_u32 v6, s33, v5
    v_mul_u32_u24 v7, 43691, v6
    v_lshrrev_b32 v7, 25, v7
    v_mul_u32_u24 v8, 768, v7
    v_sub_u32 v8, v6, v8
    v_add_u32 v7, s35, v7
    v_lshl_add_u32 v8, v7, 12, v8
    v_add_u32 v8, s36, v8
    s_add_u32 m0, s33, 20480
    s_nop 0
    buffer_load_dwordx4 v8, s[16:19], 0 offen lds
L_at_vd_17:
    s_cmp_ge_u32 s26, 3
    s_cbranch_scc1 L_at_vd_18
    s_lshl_b32 s33, s26, 10
    s_add_u32 s33, s33, 12288
    v_add_u32 v6, s33, v5
    v_mul_u32_u24 v7, 43691, v6
    v_lshrrev_b32 v7, 25, v7
    v_mul_u32_u24 v8, 768, v7
    v_sub_u32 v8, v6, v8
    v_add_u32 v7, s35, v7
    v_lshl_add_u32 v8, v7, 12, v8
    v_add_u32 v8, s36, v8
    s_add_u32 m0, s33, 20480
    s_nop 0
    buffer_load_dwordx4 v8, s[16:19], 0 offen lds
L_at_vd_18:
    s_lshl_b32 s37, s25, 2
    s_add_u32 s37, s37, s26
    s_sub_u32 s29, 8, s37
    s_cmp_lt_u32 s37, 8
    s_cselect_b32 s29, s29, 0
    v_mov_b32 v16, 0xf149f2ca
    v_mov_b32 v17, 0xf149f2ca
    v_mov_b32 v18, 0xf149f2ca
    v_mov_b32 v19, 0xf149f2ca
    v_mov_b32 v20, 0xf149f2ca
    v_mov_b32 v21, 0xf149f2ca
    v_mov_b32 v22, 0xf149f2ca
    v_mov_b32 v23, 0xf149f2ca
    v_mov_b32 v24, 0xf149f2ca
    v_mov_b32 v25, 0xf149f2ca
    v_mov_b32 v26, 0xf149f2ca
    v_mov_b32 v27, 0xf149f2ca
    v_mov_b32 v28, 0xf149f2ca
    v_mov_b32 v29, 0xf149f2ca
    v_mov_b32 v30, 0xf149f2ca
    v_mov_b32 v31, 0xf149f2ca
    v_mov_b32 v32, 0xf149f2ca
    v_mov_b32 v33, 0xf149f2ca
    v_mov_b32 v34, 0xf149f2ca
    v_mov_b32 v35, 0xf149f2ca
    v_mov_b32 v36, 0xf149f2ca
    v_mov_b32 v37, 0xf149f2ca
    v_mov_b32 v38, 0xf149f2ca
    v_mov_b32 v39, 0xf149f2ca
    v_mov_b32 v40, 0xf149f2ca
    v_mov_b32 v41, 0xf149f2ca
    v_mov_b32 v42, 0xf149f2ca
    v_mov_b32 v43, 0xf149f2ca
    v_mov_b32 v44, 0xf149f2ca
    v_mov_b32 v45, 0xf149f2ca
    v_mov_b32 v46, 0xf149f2ca
    v_mov_b32 v47, 0xf149f2ca
    v_mov_b32 v48, 0xf149f2ca
    v_mov_b32 v49, 0xf149f2ca
    v_mov_b32 v50, 0xf149f2ca
    v_mov_b32 v51, 0xf149f2ca
    v_mov_b32 v52, 0xf149f2ca
    v_mov_b32 v53, 0xf149f2ca
    v_mov_b32 v54, 0xf149f2ca
    v_mov_b32 v55, 0xf149f2ca
    v_mov_b32 v56, 0xf149f2ca
    v_mov_b32 v57, 0xf149f2ca
    v_mov_b32 v58, 0xf149f2ca
    v_mov_b32 v59, 0xf149f2ca
    v_mov_b32 v60, 0xf149f2ca
    v_mov_b32 v61, 0xf149f2ca
    v_mov_b32 v62, 0xf149f2ca
    v_mov_b32 v63, 0xf149f2ca
    v_mov_b32 v64, 0xf149f2ca
    v_mov_b32 v65, 0xf149f2ca
    v_mov_b32 v66, 0xf149f2ca
    v_mov_b32 v67, 0xf149f2ca
    v_mov_b32 v68, 0xf149f2ca
    v_mov_b32 v69, 0xf149f2ca
    v_mov_b32 v70, 0xf149f2ca
    v_mov_b32 v71, 0xf149f2ca
    v_mov_b32 v72, 0xf149f2ca
    v_mov_b32 v73, 0xf149f2ca
    v_mov_b32 v74, 0xf149f2ca
    v_mov_b32 v75, 0xf149f2ca
    v_mov_b32 v76, 0xf149f2ca
    v_mov_b32 v77, 0xf149f2ca
    v_mov_b32 v78, 0xf149f2ca
    v_mov_b32 v79, 0xf149f2ca
    v_mov_b32 v80, 0xf149f2ca
    v_mov_b32 v81, 0xf149f2ca
    v_mov_b32 v82, 0xf149f2ca
    v_mov_b32 v83, 0xf149f2ca
    v_mov_b32 v84, 0xf149f2ca
    v_mov_b32 v85, 0xf149f2ca
    v_mov_b32 v86, 0xf149f2ca
    v_mov_b32 v87, 0xf149f2ca
    v_mov_b32 v88, 0xf149f2ca
    v_mov_b32 v89, 0xf149f2ca
    v_mov_b32 v90, 0xf149f2ca
    v_mov_b32 v91, 0xf149f2ca
    v_mov_b32 v92, 0xf149f2ca
    v_mov_b32 v93, 0xf149f2ca
    v_mov_b32 v94, 0xf149f2ca
    v_mov_b32 v95, 0xf149f2ca
    v_mov_b32 v96, 0xf149f2ca
    v_mov_b32 v97, 0xf149f2ca
    v_mov_b32 v98, 0xf149f2ca
    v_mov_b32 v99, 0xf149f2ca
    v_mov_b32 v100, 0xf149f2ca
    v_mov_b32 v101, 0xf149f2ca
    v_mov_b32 v102, 0xf149f2ca
    v_mov_b32 v103, 0xf149f2ca
    v_mov_b32 v104, 0xf149f2ca
    v_mov_b32 v105, 0xf149f2ca
    v_mov_b32 v106, 0xf149f2ca
    v_mov_b32 v107, 0xf149f2ca
    v_mov_b32 v108, 0xf149f2ca
    v_mov_b32 v109, 0xf149f2ca
    v_mov_b32 v110, 0xf149f2ca
    v_mov_b32 v111, 0xf149f2ca
    v_mov_b32 v112, 0xf149f2ca
    v_mov_b32 v113, 0xf149f2ca
    v_mov_b32 v114, 0xf149f2ca
    v_mov_b32 v115, 0xf149f2ca
    v_mov_b32 v116, 0xf149f2ca
    v_mov_b32 v117, 0xf149f2ca
    v_mov_b32 v118, 0xf149f2ca
    v_mov_b32 v119, 0xf149f2ca
    v_mov_b32 v120, 0xf149f2ca
    v_mov_b32 v121, 0xf149f2ca
    v_mov_b32 v122, 0xf149f2ca
    v_mov_b32 v123, 0xf149f2ca
    v_mov_b32 v124, 0xf149f2ca
    v_mov_b32 v125, 0xf149f2ca
    v_mov_b32 v126, 0xf149f2ca
    v_mov_b32 v127, 0xf149f2ca
    v_mov_b32 v128, 0xf149f2ca
    v_mov_b32 v129, 0xf149f2ca
    v_mov_b32 v130, 0xf149f2ca
    v_mov_b32 v131, 0xf149f2ca
    v_mov_b32 v132, 0xf149f2ca
    v_mov_b32 v133, 0xf149f2ca
    v_mov_b32 v134, 0xf149f2ca
    v_mov_b32 v135, 0xf149f2ca
    v_mov_b32 v136, 0xf149f2ca
    v_mov_b32 v137, 0xf149f2ca
    v_mov_b32 v138, 0xf149f2ca
    v_mov_b32 v139, 0xf149f2ca
    v_mov_b32 v140, 0xf149f2ca
    v_mov_b32 v141, 0xf149f2ca
    v_mov_b32 v142, 0xf149f2ca
    v_mov_b32 v143, 0xf149f2ca
    v_mov_b32 v144, 0xf149f2ca
    v_mov_b32 v145, 0xf149f2ca
    v_mov_b32 v146, 0xf149f2ca
    v_mov_b32 v147, 0xf149f2ca
    v_mov_b32 v148, 0xf149f2ca
    v_mov_b32 v149, 0xf149f2ca
    v_mov_b32 v150, 0xf149f2ca
    v_mov_b32 v151, 0xf149f2ca
    v_mov_b32 v152, 0xf149f2ca
    v_mov_b32 v153, 0xf149f2ca
    v_mov_b32 v154, 0xf149f2ca
    v_mov_b32 v155, 0xf149f2ca
    v_mov_b32 v156, 0xf149f2ca
    v_mov_b32 v157, 0xf149f2ca
    v_mov_b32 v158, 0xf149f2ca
    v_mov_b32 v159, 0xf149f2ca
    s_lshl_b32 s38, s26, 5
    v_add_u32 v6, s38, v3
    v_mul_u32_u24 v6, 40, v6
    v_lshl_add_u32 v6, v4, 4, v6
    v_add_u32 v7, 15360, v6
    v_cmp_gt_u32 s[40:41], 20, v3
    v_cmp_eq_u32 s[42:43], 20, v3
    v_cndmask_b32 v8, 0, v3, s[40:41]
    v_mul_u32_u24 v8, 768, v8
    v_lshl_add_u32 v8, v4, 3, v8
    s_lshl_b32 s39, s38, 1
    v_add_u32 v8, s39, v8
    v_add_u32 v8, 20480, v8
    v_cmp_eq_u32 vcc, 0, v4
    s_waitcnt vmcnt(0)
    s_barrier
    ds_read_b64 v[160:161], v7
    ds_read_b64 v[162:163], v7 offset:8
    ds_read_b64 v[164:165], v7 offset:32
    v_mov_b32 v166, 0
    v_mov_b32 v167, 0
    ds_read_b64 v[168:169], v6 offset:0
    ds_read_b64 v[170:171], v6 offset:8
    ds_read_b64 v[172:173], v6 offset:32
    v_mov_b32 v174, 0
    v_mov_b32 v175, 0
    ds_read_b64 v[176:177], v6 offset:1280
    ds_read_b64 v[178:179], v6 offset:1288
    ds_read_b64 v[180:181], v6 offset:1312
    v_mov_b32 v182, 0
    v_mov_b32 v183, 0
    ds_read_b64 v[184:185], v6 offset:2560
    ds_read_b64 v[186:187], v6 offset:2568
    ds_read_b64 v[188:189], v6 offset:2592
    v_mov_b32 v190, 0
    v_mov_b32 v191, 0
    ds_read_b64 v[192:193], v6 offset:3840
    ds_read_b64 v[194:195], v6 offset:3848
    ds_read_b64 v[196:197], v6 offset:3872
    v_mov_b32 v198, 0
    v_mov_b32 v199, 0
    ds_read_b64 v[200:201], v6 offset:5120
    ds_read_b64 v[202:203], v6 offset:5128
    ds_read_b64 v[204:205], v6 offset:5152
    v_mov_b32 v206, 0
    v_mov_b32 v207, 0
    ds_read_b64 v[208:209], v6 offset:6400
    ds_read_b64 v[210:211], v6 offset:6408
    ds_read_b64 v[212:213], v6 offset:6432
    v_mov_b32 v214, 0
    v_mov_b32 v215, 0
    ds_read_b64 v[216:217], v6 offset:7680
    ds_read_b64 v[218:219], v6 offset:7688
    ds_read_b64 v[220:221], v6 offset:7712
    v_mov_b32 v222, 0
    v_mov_b32 v223, 0
    ds_read_b64 v[224:225], v6 offset:8960
    ds_read_b64 v[226:227], v6 offset:8968
    ds_read_b64 v[228:229], v6 offset:8992
    v_mov_b32 v230, 0
    v_mov_b32 v231, 0
    ds_read_b64 v[232:233], v6 offset:10240
    ds_read_b64 v[234:235], v6 offset:10248
    ds_read_b64 v[236:237], v6 offset:10272
    v_mov_b32 v238, 0
    v_mov_b32 v239, 0
    s_waitcnt lgkmcnt(0)
    v_cndmask_b32 v164, 0, v164, vcc
    v_cndmask_b32 v165, 0, v165, vcc
    v_cndmask_b32 v172, 0, v172, vcc
    v_cndmask_b32 v173, 0, v173, vcc
    v_cndmask_b32 v180, 0, v180, vcc
    v_cndmask_b32 v181, 0, v181, vcc
    v_cndmask_b32 v188, 0, v188, vcc
    v_cndmask_b32 v189, 0, v189, vcc
    v_cndmask_b32 v196, 0, v196, vcc
    v_cndmask_b32 v197, 0, v197, vcc
    v_cndmask_b32 v204, 0, v204, vcc
    v_cndmask_b32 v205, 0, v205, vcc
    v_cndmask_b32 v212, 0, v212, vcc
    v_cndmask_b32 v213, 0, v213, vcc
    v_cndmask_b32 v220, 0, v220, vcc
    v_cndmask_b32 v221, 0, v221, vcc
    v_cndmask_b32 v228, 0, v228, vcc
    v_cndmask_b32 v229, 0, v229, vcc
    v_cndmask_b32 v236, 0, v236, vcc
    v_cndmask_b32 v237, 0, v237, vcc
    s_nop 1
    s_cmp_gt_u32 s29, 0
    s_cbranch_scc1 L_at_sskip_19
    v_mfma_f32_32x32x16_bf16 v[16:31], v[168:171], v[160:163], 0
    v_mfma_f32_32x32x16_bf16 v[16:31], v[172:175], v[164:167], v[16:31]
L_at_sskip_19:
    s_cmp_gt_u32 s29, 1
    s_cbranch_scc1 L_at_sskip_20
    v_mfma_f32_32x32x16_bf16 v[32:47], v[176:179], v[160:163], 0
    v_mfma_f32_32x32x16_bf16 v[32:47], v[180:183], v[164:167], v[32:47]
L_at_sskip_20:
    s_cmp_gt_u32 s29, 2
    s_cbranch_scc1 L_at_sskip_21
    v_mfma_f32_32x32x16_bf16 v[48:63], v[184:187], v[160:163], 0
    v_mfma_f32_32x32x16_bf16 v[48:63], v[188:191], v[164:167], v[48:63]
L_at_sskip_21:
    s_cmp_gt_u32 s29, 3
    s_cbranch_scc1 L_at_sskip_22
    v_mfma_f32_32x32x16_bf16 v[64:79], v[192:195], v[160:163], 0
    v_mfma_f32_32x32x16_bf16 v[64:79], v[196:199], v[164:167], v[64:79]
L_at_sskip_22:
    s_cmp_gt_u32 s29, 4
    s_cbranch_scc1 L_at_sskip_23
    v_mfma_f32_32x32x16_bf16 v[80:95], v[200:203], v[160:163], 0
    v_mfma_f32_32x32x16_bf16 v[80:95], v[204:207], v[164:167], v[80:95]
L_at_sskip_23:
    s_cmp_gt_u32 s29, 5
    s_cbranch_scc1 L_at_sskip_24
    v_mfma_f32_32x32x16_bf16 v[96:111], v[208:211], v[160:163], 0
    v_mfma_f32_32x32x16_bf16 v[96:111], v[212:215], v[164:167], v[96:111]
L_at_sskip_24:
    s_cmp_gt_u32 s29, 6
    s_cbranch_scc1 L_at_sskip_25
    v_mfma_f32_32x32x16_bf16 v[112:127], v[216:219], v[160:163], 0
    v_mfma_f32_32x32x16_bf16 v[112:127], v[220:223], v[164:167], v[112:127]
L_at_sskip_25:
    s_cmp_gt_u32 s29, 7
    s_cbranch_scc1 L_at_sskip_26
    v_mfma_f32_32x32x16_bf16 v[128:143], v[224:227], v[160:163], 0
    v_mfma_f32_32x32x16_bf16 v[128:143], v[228:231], v[164:167], v[128:143]
L_at_sskip_26:
    s_cmp_gt_u32 s29, 8
    s_cbranch_scc1 L_at_sskip_27
    v_mfma_f32_32x32x16_bf16 v[144:159], v[232:235], v[160:163], 0
    v_mfma_f32_32x32x16_bf16 v[144:159], v[236:239], v[164:167], v[144:159]
L_at_sskip_27:
    s_nop 7
    ds_read_b64 v[168:169], v8 offset:0
    ds_read_b64 v[170:171], v8 offset:16
    ds_read_b64 v[172:173], v8 offset:32
    ds_read_b64 v[174:175], v8 offset:48
    ds_read_b64 v[176:177], v8 offset:64
    ds_read_b64 v[178:179], v8 offset:80
    ds_read_b64 v[180:181], v8 offset:96
    ds_read_b64 v[182:183], v8 offset:112
    ds_read_b64 v[184:185], v8 offset:128
    ds_read_b64 v[186:187], v8 offset:144
    ds_read_b64 v[188:189], v8 offset:160
    ds_read_b64 v[190:191], v8 offset:176
    ds_read_b64 v[192:193], v8 offset:192
    ds_read_b64 v[194:195], v8 offset:208
    ds_read_b64 v[196:197], v8 offset:224
    ds_read_b64 v[198:199], v8 offset:240
    ds_read_b64 v[200:201], v8 offset:256
    ds_read_b64 v[202:203], v8 offset:272
    ds_read_b64 v[204:205], v8 offset:288
    ds_read_b64 v[206:207], v8 offset:304
    ds_read_b64 v[208:209], v8 offset:320
    ds_read_b64 v[210:211], v8 offset:336
    ds_read_b64 v[212:213], v8 offset:352
    ds_read_b64 v[214:215], v8 offset:368
    ds_read_b64 v[216:217], v8 offset:384
    ds_read_b64 v[218:219], v8 offset:400
    ds_read_b64 v[220:221], v8 offset:416
    ds_read_b64 v[222:223], v8 offset:432
    ds_read_b64 v[224:225], v8 offset:448
    ds_read_b64 v[226:227], v8 offset:464
    ds_read_b64 v[228:229], v8 offset:480
    ds_read_b64 v[230:231], v8 offset:496
    ds_read_b64 v[232:233], v8 offset:512
    ds_read_b64 v[234:235], v8 offset:528
    ds_read_b64 v[236:237], v8 offset:544
    ds_read_b64 v[238:239], v8 offset:560
    s_nop 3
    v_lshlrev_b32 v242, 2, v4
    v_mov_b32 v244, 0xf149f2ca
    v_add_u32 v243, 0, v242
    v_cmp_le_u32 vcc, v243, v3
    s_nop 1
    v_cndmask_b32 v144, v244, v144, vcc
    v_cndmask_b32 v16, v16, v244, vcc
    v_add_u32 v243, 1, v242
    v_cmp_le_u32 vcc, v243, v3
    s_nop 1
    v_cndmask_b32 v145, v244, v145, vcc
    v_cndmask_b32 v17, v17, v244, vcc
    v_add_u32 v243, 2, v242
    v_cmp_le_u32 vcc, v243, v3
    s_nop 1
    v_cndmask_b32 v146, v244, v146, vcc
    v_cndmask_b32 v18, v18, v244, vcc
    v_add_u32 v243, 3, v242
    v_cmp_le_u32 vcc, v243, v3
    s_nop 1
    v_cndmask_b32 v147, v244, v147, vcc
    v_cndmask_b32 v19, v19, v244, vcc
    v_add_u32 v243, 8, v242
    v_cmp_le_u32 vcc, v243, v3
    s_nop 1
    v_cndmask_b32 v148, v244, v148, vcc
    v_cndmask_b32 v20, v20, v244, vcc
    v_add_u32 v243, 9, v242
    v_cmp_le_u32 vcc, v243, v3
    s_nop 1
    v_cndmask_b32 v149, v244, v149, vcc
    v_cndmask_b32 v21, v21, v244, vcc
    v_add_u32 v243, 10, v242
    v_cmp_le_u32 vcc, v243, v3
    s_nop 1
    v_cndmask_b32 v150, v244, v150, vcc
    v_cndmask_b32 v22, v22, v244, vcc
    v_add_u32 v243, 11, v242
    v_cmp_le_u32 vcc, v243, v3
    s_nop 1
    v_cndmask_b32 v151, v244, v151, vcc
    v_cndmask_b32 v23, v23, v244, vcc
    v_add_u32 v243, 16, v242
    v_cmp_le_u32 vcc, v243, v3
    s_nop 1
    v_cndmask_b32 v152, v244, v152, vcc
    v_cndmask_b32 v24, v24, v244, vcc
    v_add_u32 v243, 17, v242
    v_cmp_le_u32 vcc, v243, v3
    s_nop 1
    v_cndmask_b32 v153, v244, v153, vcc
    v_cndmask_b32 v25, v25, v244, vcc
    v_add_u32 v243, 18, v242
    v_cmp_le_u32 vcc, v243, v3
    s_nop 1
    v_cndmask_b32 v154, v244, v154, vcc
    v_cndmask_b32 v26, v26, v244, vcc
    v_add_u32 v243, 19, v242
    v_cmp_le_u32 vcc, v243, v3
    s_nop 1
    v_cndmask_b32 v155, v244, v155, vcc
    v_cndmask_b32 v27, v27, v244, vcc
    v_add_u32 v243, 24, v242
    v_cmp_le_u32 vcc, v243, v3
    s_nop 1
    v_cndmask_b32 v156, v244, v156, vcc
    v_cndmask_b32 v28, v28, v244, vcc
    v_add_u32 v243, 25, v242
    v_cmp_le_u32 vcc, v243, v3
    s_nop 1
    v_cndmask_b32 v157, v244, v157, vcc
    v_cndmask_b32 v29, v29, v244, vcc
    v_add_u32 v243, 26, v242
    v_cmp_le_u32 vcc, v243, v3
    s_nop 1
    v_cndmask_b32 v158, v244, v158, vcc
    v_cndmask_b32 v30, v30, v244, vcc
    v_add_u32 v243, 27, v242
    v_cmp_le_u32 vcc, v243, v3
    s_nop 1
    v_cndmask_b32 v159, v244, v159, vcc
    v_cndmask_b32 v31, v31, v244, vcc
    v_max_f32 v245, v16, v17
    v_max3_f32 v245, v245, v18, v19
    v_max3_f32 v245, v245, v20, v21
    v_max3_f32 v245, v245, v22, v23
    v_max3_f32 v245, v245, v24, v25
    v_max3_f32 v245, v245, v26, v27
    v_max3_f32 v245, v245, v28, v29
    v_max3_f32 v245, v245, v30, v31
    v_max3_f32 v245, v245, v32, v33
    v_max3_f32 v245, v245, v34, v35
    v_max3_f32 v245, v245, v36, v37
    v_max3_f32 v245, v245, v38, v39
    v_max3_f32 v245, v245, v40, v41
    v_max3_f32 v245, v245, v42, v43
    v_max3_f32 v245, v245, v44, v45
    v_max3_f32 v245, v245, v46, v47
    v_max3_f32 v245, v245, v48, v49
    v_max3_f32 v245, v245, v50, v51
    v_max3_f32 v245, v245, v52, v53
    v_max3_f32 v245, v245, v54, v55
    v_max3_f32 v245, v245, v56, v57
    v_max3_f32 v245, v245, v58, v59
    v_max3_f32 v245, v245, v60, v61
    v_max3_f32 v245, v245, v62, v63
    v_max3_f32 v245, v245, v64, v65
    v_max3_f32 v245, v245, v66, v67
    v_max3_f32 v245, v245, v68, v69
    v_max3_f32 v245, v245, v70, v71
    v_max3_f32 v245, v245, v72, v73
    v_max3_f32 v245, v245, v74, v75
    v_max3_f32 v245, v245, v76, v77
    v_max3_f32 v245, v245, v78, v79
    v_max3_f32 v245, v245, v80, v81
    v_max3_f32 v245, v245, v82, v83
    v_max3_f32 v245, v245, v84, v85
    v_max3_f32 v245, v245, v86, v87
    v_max3_f32 v245, v245, v88, v89
    v_max3_f32 v245, v245, v90, v91
    v_max3_f32 v245, v245, v92, v93
    v_max3_f32 v245, v245, v94, v95
    v_max3_f32 v245, v245, v96, v97
    v_max3_f32 v245, v245, v98, v99
    v_max3_f32 v245, v245, v100, v101
    v_max3_f32 v245, v245, v102, v103
    v_max3_f32 v245, v245, v104, v105
    v_max3_f32 v245, v245, v106, v107
    v_max3_f32 v245, v245, v108, v109
    v_max3_f32 v245, v245, v110, v111
    v_max3_f32 v245, v245, v112, v113
    v_max3_f32 v245, v245, v114, v115
    v_max3_f32 v245, v245, v116, v117
    v_max3_f32 v245, v245, v118, v119
    v_max3_f32 v245, v245, v120, v121
    v_max3_f32 v245, v245, v122, v123
    v_max3_f32 v245, v245, v124, v125
    v_max3_f32 v245, v245, v126, v127
    v_max3_f32 v245, v245, v128, v129
    v_max3_f32 v245, v245, v130, v131
    v_max3_f32 v245, v245, v132, v133
    v_max3_f32 v245, v245, v134, v135
    v_max3_f32 v245, v245, v136, v137
    v_max3_f32 v245, v245, v138, v139
    v_max3_f32 v245, v245, v140, v141
    v_max3_f32 v245, v245, v142, v143
    v_max3_f32 v245, v245, v144, v145
    v_max3_f32 v245, v245, v146, v147
    v_max3_f32 v245, v245, v148, v149
    v_max3_f32 v245, v245, v150, v151
    v_max3_f32 v245, v245, v152, v153
    v_max3_f32 v245, v245, v154, v155
    v_max3_f32 v245, v245, v156, v157
    v_max3_f32 v245, v245, v158, v159
    v_xor_b32 v246, 32, v2
    v_lshlrev_b32 v246, 2, v246
    ds_bpermute_b32 v247, v246, v245
    s_waitcnt lgkmcnt(0)
    v_max_f32 v245, v245, v247
    s_mov_b32 s32, 0x3ea52b5c
    v_mul_f32 v245, s32, v245
    v_sub_f32 v245, 0, v245
    v_fma_f32 v16, v16, s32, v245
    v_exp_f32 v16, v16
    v_fma_f32 v17, v17, s32, v245
    v_exp_f32 v17, v17
    v_fma_f32 v18, v18, s32, v245
    v_exp_f32 v18, v18
    v_fma_f32 v19, v19, s32, v245
    v_exp_f32 v19, v19
    v_fma_f32 v20, v20, s32, v245
    v_exp_f32 v20, v20
    v_fma_f32 v21, v21, s32, v245
    v_exp_f32 v21, v21
    v_fma_f32 v22, v22, s32, v245
    v_exp_f32 v22, v22
    v_fma_f32 v23, v23, s32, v245
    v_exp_f32 v23, v23
    v_fma_f32 v24, v24, s32, v245
    v_exp_f32 v24, v24
    v_fma_f32 v25, v25, s32, v245
    v_exp_f32 v25, v25
    v_fma_f32 v26, v26, s32, v245
    v_exp_f32 v26, v26
    v_fma_f32 v27, v27, s32, v245
    v_exp_f32 v27, v27
    v_fma_f32 v28, v28, s32, v245
    v_exp_f32 v28, v28
    v_fma_f32 v29, v29, s32, v245
    v_exp_f32 v29, v29
    v_fma_f32 v30, v30, s32, v245
    v_exp_f32 v30, v30
    v_fma_f32 v31, v31, s32, v245
    v_exp_f32 v31, v31
    v_fma_f32 v32, v32, s32, v245
    v_exp_f32 v32, v32
    v_fma_f32 v33, v33, s32, v245
    v_exp_f32 v33, v33
    v_fma_f32 v34, v34, s32, v245
    v_exp_f32 v34, v34
    v_fma_f32 v35, v35, s32, v245
    v_exp_f32 v35, v35
    v_fma_f32 v36, v36, s32, v245
    v_exp_f32 v36, v36
    v_fma_f32 v37, v37, s32, v245
    v_exp_f32 v37, v37
    v_fma_f32 v38, v38, s32, v245
    v_exp_f32 v38, v38
    v_fma_f32 v39, v39, s32, v245
    v_exp_f32 v39, v39
    v_fma_f32 v40, v40, s32, v245
    v_exp_f32 v40, v40
    v_fma_f32 v41, v41, s32, v245
    v_exp_f32 v41, v41
    v_fma_f32 v42, v42, s32, v245
    v_exp_f32 v42, v42
    v_fma_f32 v43, v43, s32, v245
    v_exp_f32 v43, v43
    v_fma_f32 v44, v44, s32, v245
    v_exp_f32 v44, v44
    v_fma_f32 v45, v45, s32, v245
    v_exp_f32 v45, v45
    v_fma_f32 v46, v46, s32, v245
    v_exp_f32 v46, v46
    v_fma_f32 v47, v47, s32, v245
    v_exp_f32 v47, v47
    v_fma_f32 v48, v48, s32, v245
    v_exp_f32 v48, v48
    v_fma_f32 v49, v49, s32, v245
    v_exp_f32 v49, v49
    v_fma_f32 v50, v50, s32, v245
    v_exp_f32 v50, v50
    v_fma_f32 v51, v51, s32, v245
    v_exp_f32 v51, v51
    v_fma_f32 v52, v52, s32, v245
    v_exp_f32 v52, v52
    v_fma_f32 v53, v53, s32, v245
    v_exp_f32 v53, v53
    v_fma_f32 v54, v54, s32, v245
    v_exp_f32 v54, v54
    v_fma_f32 v55, v55, s32, v245
    v_exp_f32 v55, v55
    v_fma_f32 v56, v56, s32, v245
    v_exp_f32 v56, v56
    v_fma_f32 v57, v57, s32, v245
    v_exp_f32 v57, v57
    v_fma_f32 v58, v58, s32, v245
    v_exp_f32 v58, v58
    v_fma_f32 v59, v59, s32, v245
    v_exp_f32 v59, v59
    v_fma_f32 v60, v60, s32, v245
    v_exp_f32 v60, v60
    v_fma_f32 v61, v61, s32, v245
    v_exp_f32 v61, v61
    v_fma_f32 v62, v62, s32, v245
    v_exp_f32 v62, v62
    v_fma_f32 v63, v63, s32, v245
    v_exp_f32 v63, v63
    v_fma_f32 v64, v64, s32, v245
    v_exp_f32 v64, v64
    v_fma_f32 v65, v65, s32, v245
    v_exp_f32 v65, v65
    v_fma_f32 v66, v66, s32, v245
    v_exp_f32 v66, v66
    v_fma_f32 v67, v67, s32, v245
    v_exp_f32 v67, v67
    v_fma_f32 v68, v68, s32, v245
    v_exp_f32 v68, v68
    v_fma_f32 v69, v69, s32, v245
    v_exp_f32 v69, v69
    v_fma_f32 v70, v70, s32, v245
    v_exp_f32 v70, v70
    v_fma_f32 v71, v71, s32, v245
    v_exp_f32 v71, v71
    v_fma_f32 v72, v72, s32, v245
    v_exp_f32 v72, v72
    v_fma_f32 v73, v73, s32, v245
    v_exp_f32 v73, v73
    v_fma_f32 v74, v74, s32, v245
    v_exp_f32 v74, v74
    v_fma_f32 v75, v75, s32, v245
    v_exp_f32 v75, v75
    v_fma_f32 v76, v76, s32, v245
    v_exp_f32 v76, v76
    v_fma_f32 v77, v77, s32, v245
    v_exp_f32 v77, v77
    v_fma_f32 v78, v78, s32, v245
    v_exp_f32 v78, v78
    v_fma_f32 v79, v79, s32, v245
    v_exp_f32 v79, v79
    v_fma_f32 v80, v80, s32, v245
    v_exp_f32 v80, v80
    v_fma_f32 v81, v81, s32, v245
    v_exp_f32 v81, v81
    v_fma_f32 v82, v82, s32, v245
    v_exp_f32 v82, v82
    v_fma_f32 v83, v83, s32, v245
    v_exp_f32 v83, v83
    v_fma_f32 v84, v84, s32, v245
    v_exp_f32 v84, v84
    v_fma_f32 v85, v85, s32, v245
    v_exp_f32 v85, v85
    v_fma_f32 v86, v86, s32, v245
    v_exp_f32 v86, v86
    v_fma_f32 v87, v87, s32, v245
    v_exp_f32 v87, v87
    v_fma_f32 v88, v88, s32, v245
    v_exp_f32 v88, v88
    v_fma_f32 v89, v89, s32, v245
    v_exp_f32 v89, v89
    v_fma_f32 v90, v90, s32, v245
    v_exp_f32 v90, v90
    v_fma_f32 v91, v91, s32, v245
    v_exp_f32 v91, v91
    v_fma_f32 v92, v92, s32, v245
    v_exp_f32 v92, v92
    v_fma_f32 v93, v93, s32, v245
    v_exp_f32 v93, v93
    v_fma_f32 v94, v94, s32, v245
    v_exp_f32 v94, v94
    v_fma_f32 v95, v95, s32, v245
    v_exp_f32 v95, v95
    v_fma_f32 v96, v96, s32, v245
    v_exp_f32 v96, v96
    v_fma_f32 v97, v97, s32, v245
    v_exp_f32 v97, v97
    v_fma_f32 v98, v98, s32, v245
    v_exp_f32 v98, v98
    v_fma_f32 v99, v99, s32, v245
    v_exp_f32 v99, v99
    v_fma_f32 v100, v100, s32, v245
    v_exp_f32 v100, v100
    v_fma_f32 v101, v101, s32, v245
    v_exp_f32 v101, v101
    v_fma_f32 v102, v102, s32, v245
    v_exp_f32 v102, v102
    v_fma_f32 v103, v103, s32, v245
    v_exp_f32 v103, v103
    v_fma_f32 v104, v104, s32, v245
    v_exp_f32 v104, v104
    v_fma_f32 v105, v105, s32, v245
    v_exp_f32 v105, v105
    v_fma_f32 v106, v106, s32, v245
    v_exp_f32 v106, v106
    v_fma_f32 v107, v107, s32, v245
    v_exp_f32 v107, v107
    v_fma_f32 v108, v108, s32, v245
    v_exp_f32 v108, v108
    v_fma_f32 v109, v109, s32, v245
    v_exp_f32 v109, v109
    v_fma_f32 v110, v110, s32, v245
    v_exp_f32 v110, v110
    v_fma_f32 v111, v111, s32, v245
    v_exp_f32 v111, v111
    v_fma_f32 v112, v112, s32, v245
    v_exp_f32 v112, v112
    v_fma_f32 v113, v113, s32, v245
    v_exp_f32 v113, v113
    v_fma_f32 v114, v114, s32, v245
    v_exp_f32 v114, v114
    v_fma_f32 v115, v115, s32, v245
    v_exp_f32 v115, v115
    v_fma_f32 v116, v116, s32, v245
    v_exp_f32 v116, v116
    v_fma_f32 v117, v117, s32, v245
    v_exp_f32 v117, v117
    v_fma_f32 v118, v118, s32, v245
    v_exp_f32 v118, v118
    v_fma_f32 v119, v119, s32, v245
    v_exp_f32 v119, v119
    v_fma_f32 v120, v120, s32, v245
    v_exp_f32 v120, v120
    v_fma_f32 v121, v121, s32, v245
    v_exp_f32 v121, v121
    v_fma_f32 v122, v122, s32, v245
    v_exp_f32 v122, v122
    v_fma_f32 v123, v123, s32, v245
    v_exp_f32 v123, v123
    v_fma_f32 v124, v124, s32, v245
    v_exp_f32 v124, v124
    v_fma_f32 v125, v125, s32, v245
    v_exp_f32 v125, v125
    v_fma_f32 v126, v126, s32, v245
    v_exp_f32 v126, v126
    v_fma_f32 v127, v127, s32, v245
    v_exp_f32 v127, v127
    v_fma_f32 v128, v128, s32, v245
    v_exp_f32 v128, v128
    v_fma_f32 v129, v129, s32, v245
    v_exp_f32 v129, v129
    v_fma_f32 v130, v130, s32, v245
    v_exp_f32 v130, v130
    v_fma_f32 v131, v131, s32, v245
    v_exp_f32 v131, v131
    v_fma_f32 v132, v132, s32, v245
    v_exp_f32 v132, v132
    v_fma_f32 v133, v133, s32, v245
    v_exp_f32 v133, v133
    v_fma_f32 v134, v134, s32, v245
    v_exp_f32 v134, v134
    v_fma_f32 v135, v135, s32, v245
    v_exp_f32 v135, v135
    v_fma_f32 v136, v136, s32, v245
    v_exp_f32 v136, v136
    v_fma_f32 v137, v137, s32, v245
    v_exp_f32 v137, v137
    v_fma_f32 v138, v138, s32, v245
    v_exp_f32 v138, v138
    v_fma_f32 v139, v139, s32, v245
    v_exp_f32 v139, v139
    v_fma_f32 v140, v140, s32, v245
    v_exp_f32 v140, v140
    v_fma_f32 v141, v141, s32, v245
    v_exp_f32 v141, v141
    v_fma_f32 v142, v142, s32, v245
    v_exp_f32 v142, v142
    v_fma_f32 v143, v143, s32, v245
    v_exp_f32 v143, v143
    v_fma_f32 v144, v144, s32, v245
    v_exp_f32 v144, v144
    v_fma_f32 v145, v145, s32, v245
    v_exp_f32 v145, v145
    v_fma_f32 v146, v146, s32, v245
    v_exp_f32 v146, v146
    v_fma_f32 v147, v147, s32, v245
    v_exp_f32 v147, v147
    v_fma_f32 v148, v148, s32, v245
    v_exp_f32 v148, v148
    v_fma_f32 v149, v149, s32, v245
    v_exp_f32 v149, v149
    v_fma_f32 v150, v150, s32, v245
    v_exp_f32 v150, v150
    v_fma_f32 v151, v151, s32, v245
    v_exp_f32 v151, v151
    v_fma_f32 v152, v152, s32, v245
    v_exp_f32 v152, v152
    v_fma_f32 v153, v153, s32, v245
    v_exp_f32 v153, v153
    v_fma_f32 v154, v154, s32, v245
    v_exp_f32 v154, v154
    v_fma_f32 v155, v155, s32, v245
    v_exp_f32 v155, v155
    v_fma_f32 v156, v156, s32, v245
    v_exp_f32 v156, v156
    v_fma_f32 v157, v157, s32, v245
    v_exp_f32 v157, v157
    v_fma_f32 v158, v158, s32, v245
    v_exp_f32 v158, v158
    v_fma_f32 v159, v159, s32, v245
    v_exp_f32 v159, v159
    s_nop 0
    v_cvt_pk_bf16_f32 v16, v16, v17
    v_cvt_pk_bf16_f32 v17, v18, v19
    v_cvt_pk_bf16_f32 v18, v20, v21
    v_cvt_pk_bf16_f32 v19, v22, v23
    v_cvt_pk_bf16_f32 v20, v24, v25
    v_cvt_pk_bf16_f32 v21, v26, v27
    v_cvt_pk_bf16_f32 v22, v28, v29
    v_cvt_pk_bf16_f32 v23, v30, v31
    v_cvt_pk_bf16_f32 v32, v32, v33
    v_cvt_pk_bf16_f32 v33, v34, v35
    v_cvt_pk_bf16_f32 v34, v36, v37
    v_cvt_pk_bf16_f32 v35, v38, v39
    v_cvt_pk_bf16_f32 v36, v40, v41
    v_cvt_pk_bf16_f32 v37, v42, v43
    v_cvt_pk_bf16_f32 v38, v44, v45
    v_cvt_pk_bf16_f32 v39, v46, v47
    v_cvt_pk_bf16_f32 v48, v48, v49
    v_cvt_pk_bf16_f32 v49, v50, v51
    v_cvt_pk_bf16_f32 v50, v52, v53
    v_cvt_pk_bf16_f32 v51, v54, v55
    v_cvt_pk_bf16_f32 v52, v56, v57
    v_cvt_pk_bf16_f32 v53, v58, v59
    v_cvt_pk_bf16_f32 v54, v60, v61
    v_cvt_pk_bf16_f32 v55, v62, v63
    v_cvt_pk_bf16_f32 v64, v64, v65
    v_cvt_pk_bf16_f32 v65, v66, v67
    v_cvt_pk_bf16_f32 v66, v68, v69
    v_cvt_pk_bf16_f32 v67, v70, v71
    v_cvt_pk_bf16_f32 v68, v72, v73
    v_cvt_pk_bf16_f32 v69, v74, v75
    v_cvt_pk_bf16_f32 v70, v76, v77
    v_cvt_pk_bf16_f32 v71, v78, v79
    v_cvt_pk_bf16_f32 v80, v80, v81
    v_cvt_pk_bf16_f32 v81, v82, v83
    v_cvt_pk_bf16_f32 v82, v84, v85
    v_cvt_pk_bf16_f32 v83, v86, v87
    v_cvt_pk_bf16_f32 v84, v88, v89
    v_cvt_pk_bf16_f32 v85, v90, v91
    v_cvt_pk_bf16_f32 v86, v92, v93
    v_cvt_pk_bf16_f32 v87, v94, v95
    v_cvt_pk_bf16_f32 v96, v96, v97
    v_cvt_pk_bf16_f32 v97, v98, v99
    v_cvt_pk_bf16_f32 v98, v100, v101
    v_cvt_pk_bf16_f32 v99, v102, v103
    v_cvt_pk_bf16_f32 v100, v104, v105
    v_cvt_pk_bf16_f32 v101, v106, v107
    v_cvt_pk_bf16_f32 v102, v108, v109
    v_cvt_pk_bf16_f32 v103, v110, v111
    v_cvt_pk_bf16_f32 v112, v112, v113
    v_cvt_pk_bf16_f32 v113, v114, v115
    v_cvt_pk_bf16_f32 v114, v116, v117
    v_cvt_pk_bf16_f32 v115, v118, v119
    v_cvt_pk_bf16_f32 v116, v120, v121
    v_cvt_pk_bf16_f32 v117, v122, v123
    v_cvt_pk_bf16_f32 v118, v124, v125
    v_cvt_pk_bf16_f32 v119, v126, v127
    v_cvt_pk_bf16_f32 v128, v128, v129
    v_cvt_pk_bf16_f32 v129, v130, v131
    v_cvt_pk_bf16_f32 v130, v132, v133
    v_cvt_pk_bf16_f32 v131, v134, v135
    v_cvt_pk_bf16_f32 v132, v136, v137
    v_cvt_pk_bf16_f32 v133, v138, v139
    v_cvt_pk_bf16_f32 v134, v140, v141
    v_cvt_pk_bf16_f32 v135, v142, v143
    v_cvt_pk_bf16_f32 v144, v144, v145
    v_cvt_pk_bf16_f32 v145, v146, v147
    v_cvt_pk_bf16_f32 v146, v148, v149
    v_cvt_pk_bf16_f32 v147, v150, v151
    v_cvt_pk_bf16_f32 v148, v152, v153
    v_cvt_pk_bf16_f32 v149, v154, v155
    v_cvt_pk_bf16_f32 v150, v156, v157
    v_cvt_pk_bf16_f32 v151, v158, v159
    v_mov_b32 v244, 0x3f803f80
    s_nop 1
    v_cndmask_b32 v243, 0, v244, s[42:43]
    v_cndmask_b32 v168, v243, v168, s[40:41]
    v_cndmask_b32 v169, v243, v169, s[40:41]
    v_cndmask_b32 v170, v243, v170, s[40:41]
    v_cndmask_b32 v171, v243, v171, s[40:41]
    v_cndmask_b32 v172, v243, v172, s[40:41]
    v_cndmask_b32 v173, v243, v173, s[40:41]
    v_cndmask_b32 v174, v243, v174, s[40:41]
    v_cndmask_b32 v175, v243, v175, s[40:41]
    v_cndmask_b32 v176, v243, v176, s[40:41]
    v_cndmask_b32 v177, v243, v177, s[40:41]
    v_cndmask_b32 v178, v243, v178, s[40:41]
    v_cndmask_b32 v179, v243, v179, s[40:41]
    v_cndmask_b32 v180, v243, v180, s[40:41]
    v_cndmask_b32 v181, v243, v181, s[40:41]
    v_cndmask_b32 v182, v243, v182, s[40:41]
    v_cndmask_b32 v183, v243, v183, s[40:41]
    v_cndmask_b32 v184, v243, v184, s[40:41]
    v_cndmask_b32 v185, v243, v185, s[40:41]
    v_cndmask_b32 v186, v243, v186, s[40:41]
    v_cndmask_b32 v187, v243, v187, s[40:41]
    v_cndmask_b32 v188, v243, v188, s[40:41]
    v_cndmask_b32 v189, v243, v189, s[40:41]
    v_cndmask_b32 v190, v243, v190, s[40:41]
    v_cndmask_b32 v191, v243, v191, s[40:41]
    v_cndmask_b32 v192, v243, v192, s[40:41]
    v_cndmask_b32 v193, v243, v193, s[40:41]
    v_cndmask_b32 v194, v243, v194, s[40:41]
    v_cndmask_b32 v195, v243, v195, s[40:41]
    v_cndmask_b32 v196, v243, v196, s[40:41]
    v_cndmask_b32 v197, v243, v197, s[40:41]
    v_cndmask_b32 v198, v243, v198, s[40:41]
    v_cndmask_b32 v199, v243, v199, s[40:41]
    v_cndmask_b32 v200, v243, v200, s[40:41]
    v_cndmask_b32 v201, v243, v201, s[40:41]
    v_cndmask_b32 v202, v243, v202, s[40:41]
    v_cndmask_b32 v203, v243, v203, s[40:41]
    v_cndmask_b32 v204, v243, v204, s[40:41]
    v_cndmask_b32 v205, v243, v205, s[40:41]
    v_cndmask_b32 v206, v243, v206, s[40:41]
    v_cndmask_b32 v207, v243, v207, s[40:41]
    v_cndmask_b32 v208, v243, v208, s[40:41]
    v_cndmask_b32 v209, v243, v209, s[40:41]
    v_cndmask_b32 v210, v243, v210, s[40:41]
    v_cndmask_b32 v211, v243, v211, s[40:41]
    v_cndmask_b32 v212, v243, v212, s[40:41]
    v_cndmask_b32 v213, v243, v213, s[40:41]
    v_cndmask_b32 v214, v243, v214, s[40:41]
    v_cndmask_b32 v215, v243, v215, s[40:41]
    v_cndmask_b32 v216, v243, v216, s[40:41]
    v_cndmask_b32 v217, v243, v217, s[40:41]
    v_cndmask_b32 v218, v243, v218, s[40:41]
    v_cndmask_b32 v219, v243, v219, s[40:41]
    v_cndmask_b32 v220, v243, v220, s[40:41]
    v_cndmask_b32 v221, v243, v221, s[40:41]
    v_cndmask_b32 v222, v243, v222, s[40:41]
    v_cndmask_b32 v223, v243, v223, s[40:41]
    v_cndmask_b32 v224, v243, v224, s[40:41]
    v_cndmask_b32 v225, v243, v225, s[40:41]
    v_cndmask_b32 v226, v243, v226, s[40:41]
    v_cndmask_b32 v227, v243, v227, s[40:41]
    v_cndmask_b32 v228, v243, v228, s[40:41]
    v_cndmask_b32 v229, v243, v229, s[40:41]
    v_cndmask_b32 v230, v243, v230, s[40:41]
    v_cndmask_b32 v231, v243, v231, s[40:41]
    v_cndmask_b32 v232, v243, v232, s[40:41]
    v_cndmask_b32 v233, v243, v233, s[40:41]
    v_cndmask_b32 v234, v243, v234, s[40:41]
    v_cndmask_b32 v235, v243, v235, s[40:41]
    v_cndmask_b32 v236, v243, v236, s[40:41]
    v_cndmask_b32 v237, v243, v237, s[40:41]
    v_cndmask_b32 v238, v243, v238, s[40:41]
    v_cndmask_b32 v239, v243, v239, s[40:41]
    v_mov_b32 v240, 0
    v_mov_b32 v241, 0
    v_mov_b32 v242, 0
    v_mov_b32 v243, 0
    v_mov_b32 v244, 0
    v_mov_b32 v245, 0
    v_mov_b32 v246, 0
    v_mov_b32 v247, 0
    v_mov_b32 v248, 0
    v_mov_b32 v249, 0
    v_mov_b32 v250, 0
    v_mov_b32 v251, 0
    v_mov_b32 v252, 0
    v_mov_b32 v253, 0
    v_mov_b32 v254, 0
    v_mov_b32 v255, 0
    s_nop 1
    s_cmp_gt_u32 s29, 0
    s_cbranch_scc1 L_at_pskip_28
    v_mfma_f32_32x32x16_bf16 v[240:255], v[168:171], v[16:19], v[240:255]
    v_mfma_f32_32x32x16_bf16 v[240:255], v[172:175], v[20:23], v[240:255]
L_at_pskip_28:
    s_cmp_gt_u32 s29, 1
    s_cbranch_scc1 L_at_pskip_29
    v_mfma_f32_32x32x16_bf16 v[240:255], v[176:179], v[32:35], v[240:255]
    v_mfma_f32_32x32x16_bf16 v[240:255], v[180:183], v[36:39], v[240:255]
L_at_pskip_29:
    s_cmp_gt_u32 s29, 2
    s_cbranch_scc1 L_at_pskip_30
    v_mfma_f32_32x32x16_bf16 v[240:255], v[184:187], v[48:51], v[240:255]
    v_mfma_f32_32x32x16_bf16 v[240:255], v[188:191], v[52:55], v[240:255]
L_at_pskip_30:
    s_cmp_gt_u32 s29, 3
    s_cbranch_scc1 L_at_pskip_31
    v_mfma_f32_32x32x16_bf16 v[240:255], v[192:195], v[64:67], v[240:255]
    v_mfma_f32_32x32x16_bf16 v[240:255], v[196:199], v[68:71], v[240:255]
L_at_pskip_31:
    s_cmp_gt_u32 s29, 4
    s_cbranch_scc1 L_at_pskip_32
    v_mfma_f32_32x32x16_bf16 v[240:255], v[200:203], v[80:83], v[240:255]
    v_mfma_f32_32x32x16_bf16 v[240:255], v[204:207], v[84:87], v[240:255]
L_at_pskip_32:
    s_cmp_gt_u32 s29, 5
    s_cbranch_scc1 L_at_pskip_33
    v_mfma_f32_32x32x16_bf16 v[240:255], v[208:211], v[96:99], v[240:255]
    v_mfma_f32_32x32x16_bf16 v[240:255], v[212:215], v[100:103], v[240:255]
L_at_pskip_33:
    s_cmp_gt_u32 s29, 6
    s_cbranch_scc1 L_at_pskip_34
    v_mfma_f32_32x32x16_bf16 v[240:255], v[216:219], v[112:115], v[240:255]
    v_mfma_f32_32x32x16_bf16 v[240:255], v[220:223], v[116:119], v[240:255]
L_at_pskip_34:
    s_cmp_gt_u32 s29, 7
    s_cbranch_scc1 L_at_pskip_35
    v_mfma_f32_32x32x16_bf16 v[240:255], v[224:227], v[128:131], v[240:255]
    v_mfma_f32_32x32x16_bf16 v[240:255], v[228:231], v[132:135], v[240:255]
L_at_pskip_35:
    s_cmp_gt_u32 s29, 8
    s_cbranch_scc1 L_at_pskip_36
    v_mfma_f32_32x32x16_bf16 v[240:255], v[232:235], v[144:147], v[240:255]
    v_mfma_f32_32x32x16_bf16 v[240:255], v[236:239], v[148:151], v[240:255]
L_at_pskip_36:
    s_nop 15
    v_or_b32 v10, 32, v2
    v_lshlrev_b32 v10, 2, v10
    ds_bpermute_b32 v11, v10, v248
    s_waitcnt lgkmcnt(0)
    v_rcp_f32 v11, v11
    s_nop 0
    v_mul_f32 v240, v240, v11
    v_mul_f32 v241, v241, v11
    v_mul_f32 v242, v242, v11
    v_mul_f32 v243, v243, v11
    v_mul_f32 v244, v244, v11
    v_mul_f32 v245, v245, v11
    v_mul_f32 v246, v246, v11
    v_mul_f32 v247, v247, v11
    v_mul_f32 v248, v248, v11
    v_mul_f32 v249, v249, v11
    v_mul_f32 v250, v250, v11
    v_mul_f32 v251, v251, v11
    v_cvt_pk_bf16_f32 v240, v240, v241
    v_cvt_pk_bf16_f32 v241, v242, v243
    v_cvt_pk_bf16_f32 v244, v244, v245
    v_cvt_pk_bf16_f32 v245, v246, v247
    v_cvt_pk_bf16_f32 v248, v248, v249
    v_cvt_pk_bf16_f32 v249, v250, v251
    s_add_u32 s38, s38, s27
    v_add_u32 v12, s38, v3
    v_mul_u32_u24 v12, 1280, v12
    v_lshl_add_u32 v12, v4, 3, v12
    s_mul_i32 s28, s24, 40
    v_add_u32 v12, s28, v12
    buffer_store_dwordx2 v[240:241], v12, s[20:23], 0 offen
    buffer_store_dwordx2 v[244:245], v12, s[20:23], 0 offen offset:16
    v_cmp_eq_u32 vcc, 0, v4
    s_and_saveexec_b64 s[44:45], vcc
    buffer_store_dwordx2 v[248:249], v12, s[20:23], 0 offen offset:32
L_at_end_9:
    s_endpgm
.globl gemm2_kernel
.p2align 8
.type gemm2_kernel,@function
gemm2_kernel:
    s_cmp_ge_u32 s2, 160
    s_cbranch_scc1 L_g2_end_37
    s_load_dwordx2 s[4:5], s[0:1], 16
    s_load_dwordx2 s[6:7], s[0:1], 40
    s_load_dwordx2 s[8:9], s[0:1], 64
    s_load_dwordx2 s[10:11], s[0:1], 0
    s_load_dwordx2 s[50:51], s[0:1], 48
    s_and_b32 s24, s2, 15
    s_lshr_b32 s25, s2, 4
    v_lshrrev_b32 v1, 6, v0
    s_nop 0
    v_readfirstlane_b32 s26, v1
    v_and_b32 v2, 63, v0
    s_waitcnt lgkmcnt(0)
    s_lshr_b32 s29, s26, 1
    s_and_b32 s30, s26, 1
    v_and_b32 v3, 31, v2
    v_lshrrev_b32 v4, 5, v2
    s_lshl_b32 s31, s24, 7
    s_lshl_b32 s32, s29, 6
    s_add_u32 s31, s31, s32
    v_add_u32 v5, s31, v3
    v_lshrrev_b32 v8, 3, v2
    v_lshrrev_b32 v9, 4, v2
    s_and_b32 s33, s26, 1
    s_lshl_b32 s33, s33, 2
    v_add_u32 v9, s33, v9
    v_and_b32 v10, 7, v2
    v_xor_b32 v9, v9, v10
    v_lshlrev_b32 v9, 4, v9
    s_lshl_b32 s34, s24, 7
    s_lshl_b32 s35, s26, 3
    s_add_u32 s34, s34, s35
    s_lshl_b32 s36, s26, 10
    v_lshrrev_b32 v10, 3, v2
    v_and_b32 v11, 7, v2
    v_bfe_u32 v12, v2, 4, 1
    v_lshlrev_b32 v12, 2, v12
    v_xor_b32 v11, v11, v12
    v_lshlrev_b32 v11, 4, v11
    v_mul_u32_u24 v10, 1280, v10
    s_lshl_b32 s28, s25, 7
    v_add3_u32 v128, v10, v11, s28
    s_lshl_b32 s37, s26, 11
    s_mov_b32 s46, 81920
    v_add_u32 v10, s32, v3
    v_bfe_u32 v11, v10, 1, 3
    v_lshlrev_b32 v12, 2, v4
    v_xor_b32 v11, v11, v12
    v_lshlrev_b32 v10, 7, v10
    v_xor_b32 v12, 0, v11
    v_lshl_add_u32 v16, v12, 4, v10
    v_xor_b32 v12, 1, v11
    v_lshl_add_u32 v17, v12, 4, v10
    v_xor_b32 v12, 2, v11
    v_lshl_add_u32 v18, v12, 4, v10
    v_xor_b32 v12, 3, v11
    v_lshl_add_u32 v19, v12, 4, v10
    v_bfe_u32 v10, v2, 2, 2
    v_and_b32 v11, 3, v2
    v_bfe_u32 v12, v2, 4, 1
    v_lshl_add_u32 v13, v4, 5, v10
    v_lshlrev_b32 v13, 7, v13
    v_lshl_add_u32 v13, v12, 5, v13
    v_lshl_add_u32 v13, v11, 3, v13
    v_bfe_u32 v14, v10, 1, 1
    v_xor_b32 v14, s30, v14
    v_lshl_add_u32 v14, v14, 6, v13
    s_add_u32 s12, s8, 0x1800000
    s_addc_u32 s13, s9, 0
    s_and_b32 s13, s13, 0xffff
    s_mov_b32 s14, 0x280000
    s_mov_b32 s15, 0x20000
    s_mov_b32 s16, s4
    s_and_b32 s17, s5, 0xffff
    s_mov_b32 s18, 0xc8000
    s_mov_b32 s19, 0x20000
    s_add_u32 s56, s8, 0x1000000
    s_addc_u32 s57, s9, 0
    s_and_b32 s57, s57, 0xffff
    s_mov_b32 s58, 0x600000
    s_mov_b32 s59, 0x20000
    s_mov_b32 s60, s6
    s_and_b32 s61, s7, 0xffff
    s_mov_b32 s62, 0x1e0000
    s_mov_b32 s63, 0x20000
    v_mul_u32_u24 v129, 1280, v8
    v_add_u32 v129, v129, v9
    s_mul_i32 s40, s34, 1280
    s_add_u32 s41, s40, 40960
    s_add_u32 s42, s40, 81920
    s_add_u32 s43, s40, 122880
    s_mul_i32 s44, s26, 20480
    s_add_u32 s45, s44, 10240
    v_mul_u32_u24 v130, 3072, v8
    v_add_u32 v130, v130, v9
    s_mul_i32 s64, s34, 3072
    s_add_u32 s65, s64, 98304
    s_add_u32 s66, s64, 196608
    s_add_u32 s67, s64, 294912
    s_mul_i32 s68, s26, 20480
    s_add_u32 s69, s68, 10240
    v_add_u32 v22, 0x6000, v16
    v_add_u32 v23, 0x6000, v17
    v_add_u32 v24, 0x6000, v18
    v_add_u32 v25, 0x6000, v19
    v_add_u32 v20, 0x6000, v14
    v_add_u32 v28, 0xc000, v16
    v_add_u32 v29, 0xc000, v17
    v_add_u32 v30, 0xc000, v18
    v_add_u32 v31, 0xc000, v19
    v_add_u32 v26, 0xc000, v14
    v_add_u32 v34, 0x12000, v16
    v_add_u32 v35, 0x12000, v17
    v_add_u32 v36, 0x12000, v18
    v_add_u32 v37, 0x12000, v19
    v_add_u32 v32, 0x12000, v14
    v_add_u32 v40, 0x18000, v16
    v_add_u32 v41, 0x18000, v17
    v_add_u32 v42, 0x18000, v18
    v_add_u32 v43, 0x18000, v19
    v_add_u32 v38, 0x18000, v14
    s_add_u32 m0, s36, 0x0
    s_nop 0
    buffer_load_dwordx4 v129, s[12:15], s40 offen lds
    s_add_u32 s40, s40, 128
    s_add_u32 m0, s36, 0x1000
    s_nop 0
    buffer_load_dwordx4 v129, s[12:15], s41 offen lds
    s_add_u32 s41, s41, 128
    s_add_u32 m0, s36, 0x2000
    s_nop 0
    buffer_load_dwordx4 v129, s[12:15], s42 offen lds
    s_add_u32 s42, s42, 128
    s_add_u32 m0, s36, 0x3000
    s_nop 0
    buffer_load_dwordx4 v129, s[12:15], s43 offen lds
    s_add_u32 s43, s43, 128
    s_add_u32 m0, s37, 0x4000
    s_nop 0
    buffer_load_dwordx4 v128, s[16:19], s44 offen lds
    s_add_u32 s44, s44, s46
    s_add_u32 m0, s37, 0x4400
    s_nop 0
    buffer_load_dwordx4 v128, s[16:19], s45 offen lds
    s_add_u32 s45, s45, s46
    s_add_u32 m0, s36, 0x6000
    s_nop 0
    buffer_load_dwordx4 v129, s[12:15], s40 offen lds
    s_add_u32 s40, s40, 128
    s_add_u32 m0, s36, 0x7000
    s_nop 0
    buffer_load_dwordx4 v129, s[12:15], s41 offen lds
    s_add_u32 s41, s41, 128
    s_add_u32 m0, s36, 0x8000
    s_nop 0
    buffer_load_dwordx4 v129, s[12:15], s42 offen lds
    s_add_u32 s42, s42, 128
    s_add_u32 m0, s36, 0x9000
    s_nop 0
    buffer_load_dwordx4 v129, s[12:15], s43 offen lds
    s_add_u32 s43, s43, 128
    s_add_u32 m0, s37, 0xa000
    s_nop 0
    buffer_load_dwordx4 v128, s[16:19], s44 offen lds
    s_add_u32 s44, s44, s46
    s_add_u32 m0, s37, 0xa400
    s_nop 0
    buffer_load_dwordx4 v128, s[16:19], s45 offen lds
    s_add_u32 s45, s45, s46
    s_add_u32 m0, s36, 0xc000
    s_nop 0
    buffer_load_dwordx4 v129, s[12:15], s40 offen lds
    s_add_u32 s40, s40, 128
    s_add_u32 m0, s36, 0xd000
    s_nop 0
    buffer_load_dwordx4 v129, s[12:15], s41 offen lds
    s_add_u32 s41, s41, 128
    s_add_u32 m0, s36, 0xe000
    s_nop 0
    buffer_load_dwordx4 v129, s[12:15], s42 offen lds
    s_add_u32 s42, s42, 128
    s_add_u32 m0, s36, 0xf000
    s_nop 0
    buffer_load_dwordx4 v129, s[12:15], s43 offen lds
    s_add_u32 s43, s43, 128
    s_add_u32 m0, s37, 0x10000
    s_nop 0
    buffer_load_dwordx4 v128, s[16:19], s44 offen lds
    s_add_u32 s44, s44, s46
    s_add_u32 m0, s37, 0x10400
    s_nop 0
    buffer_load_dwordx4 v128, s[16:19], s45 offen lds
    s_add_u32 s45, s45, s46
    s_add_u32 m0, s36, 0x12000
    s_nop 0
    buffer_load_dwordx4 v129, s[12:15], s40 offen lds
    s_add_u32 s40, s40, 128
    s_add_u32 m0, s36, 0x13000
    s_nop 0
    buffer_load_dwordx4 v129, s[12:15], s41 offen lds
    s_add_u32 s41, s41, 128
    s_add_u32 m0, s36, 0x14000
    s_nop 0
    buffer_load_dwordx4 v129, s[12:15], s42 offen lds
    s_add_u32 s42, s42, 128
    s_add_u32 m0, s36, 0x15000
    s_nop 0
    buffer_load_dwordx4 v129, s[12:15], s43 offen lds
    s_add_u32 s43, s43, 128
    s_add_u32 m0, s37, 0x16000
    s_nop 0
    buffer_load_dwordx4 v128, s[16:19], s44 offen lds
    s_add_u32 s44, s44, s46
    s_add_u32 m0, s37, 0x16400
    s_nop 0
    buffer_load_dwordx4 v128, s[16:19], s45 offen lds
    s_add_u32 s45, s45, s46
    s_waitcnt vmcnt(18)
    s_barrier
    s_add_u32 m0, s36, 0x18000
    s_nop 0
    buffer_load_dwordx4 v129, s[12:15], s40 offen lds
    s_add_u32 s40, s40, 128
    s_add_u32 m0, s36, 0x19000
    s_nop 0
    buffer_load_dwordx4 v129, s[12:15], s41 offen lds
    s_add_u32 s41, s41, 128
    s_add_u32 m0, s36, 0x1a000
    s_nop 0
    buffer_load_dwordx4 v129, s[12:15], s42 offen lds
    s_add_u32 s42, s42, 128
    s_add_u32 m0, s36, 0x1b000
    s_nop 0
    buffer_load_dwordx4 v129, s[12:15], s43 offen lds
    s_add_u32 s43, s43, 128
    s_add_u32 m0, s37, 0x1c000
    s_nop 0
    buffer_load_dwordx4 v128, s[16:19], s44 offen lds
    s_add_u32 s44, s44, s46
    s_add_u32 m0, s37, 0x1c400
    s_nop 0
    buffer_load_dwordx4 v128, s[16:19], s45 offen lds
    s_add_u32 s45, s45, s46
    ds_read_b128 v[132:135], v16 offset:0
    ds_read_b128 v[136:139], v16 offset:4096
    ds_read_b64_tr_b16 v[44:45], v14 offset:16384
    ds_read_b64_tr_b16 v[46:47], v14 offset:16896
    ds_read_b128 v[140:143], v17 offset:0
    ds_read_b128 v[144:147], v17 offset:4096
    ds_read_b64_tr_b16 v[48:49], v14 offset:17408
    ds_read_b64_tr_b16 v[50:51], v14 offset:17920
    s_waitcnt lgkmcnt(4)
    v_mfma_f32_32x32x16_bf16 v[64:79], v[44:47], v[132:135], 0
    v_mfma_f32_32x32x16_bf16 v[80:95], v[44:47], v[136:139], 0
    ds_read_b128 v[132:135], v18 offset:0
    ds_read_b128 v[136:139], v18 offset:4096
    ds_read_b64_tr_b16 v[44:45], v14 offset:18432
    ds_read_b64_tr_b16 v[46:47], v14 offset:18944
    s_waitcnt lgkmcnt(4)
    v_mfma_f32_32x32x16_bf16 v[64:79], v[48:51], v[140:143], v[64:79]
    v_mfma_f32_32x32x16_bf16 v[80:95], v[48:51], v[144:147], v[80:95]
    ds_read_b128 v[140:143], v19 offset:0
    ds_read_b128 v[144:147], v19 offset:4096
    ds_read_b64_tr_b16 v[48:49], v14 offset:19456
    ds_read_b64_tr_b16 v[50:51], v14 offset:19968
    s_waitcnt lgkmcnt(4)
    v_mfma_f32_32x32x16_bf16 v[64:79], v[44:47], v[132:135], v[64:79]
    v_mfma_f32_32x32x16_bf16 v[80:95], v[44:47], v[136:139], v[80:95]
    s_waitcnt lgkmcnt(0)
    v_mfma_f32_32x32x16_bf16 v[64:79], v[48:51], v[140:143], v[64:79]
    v_mfma_f32_32x32x16_bf16 v[80:95], v[48:51], v[144:147], v[80:95]
    s_waitcnt vmcnt(18)
    s_barrier
    s_add_u32 m0, s36, 0x0
    s_nop 0
    buffer_load_dwordx4 v129, s[12:15], s40 offen lds
    s_add_u32 s40, s40, 128
    s_add_u32 m0, s36, 0x1000
    s_nop 0
    buffer_load_dwordx4 v129, s[12:15], s41 offen lds
    s_add_u32 s41, s41, 128
    s_add_u32 m0, s36, 0x2000
    s_nop 0
    buffer_load_dwordx4 v129, s[12:15], s42 offen lds
    s_add_u32 s42, s42, 128
    s_add_u32 m0, s36, 0x3000
    s_nop 0
    buffer_load_dwordx4 v129, s[12:15], s43 offen lds
    s_add_u32 s43, s43, 128
    s_add_u32 m0, s37, 0x4000
    s_nop 0
    buffer_load_dwordx4 v128, s[16:19], s44 offen lds
    s_add_u32 s44, s44, s46
    s_add_u32 m0, s37, 0x4400
    s_nop 0
    buffer_load_dwordx4 v128, s[16:19], s45 offen lds
    s_add_u32 s45, s45, s46
    ds_read_b128 v[132:135], v22 offset:0
    ds_read_b128 v[136:139], v22 offset:4096
    ds_read_b64_tr_b16 v[44:45], v20 offset:16384
    ds_read_b64_tr_b16 v[46:47], v20 offset:16896
    ds_read_b128 v[140:143], v23 offset:0
    ds_read_b128 v[144:147], v23 offset:4096
    ds_read_b64_tr_b16 v[48:49], v20 offset:17408
    ds_read_b64_tr_b16 v[50:51], v20 offset:17920
    s_waitcnt lgkmcnt(4)
    v_mfma_f32_32x32x16_bf16 v[64:79], v[44:47], v[132:135], v[64:79]
    v_mfma_f32_32x32x16_bf16 v[80:95], v[44:47], v[136:139], v[80:95]
    ds_read_b128 v[132:135], v24 offset:0
    ds_read_b128 v[136:139], v24 offset:4096
    ds_read_b64_tr_b16 v[44:45], v20 offset:18432
    ds_read_b64_tr_b16 v[46:47], v20 offset:18944
    s_waitcnt lgkmcnt(4)
    v_mfma_f32_32x32x16_bf16 v[64:79], v[48:51], v[140:143], v[64:79]
    v_mfma_f32_32x32x16_bf16 v[80:95], v[48:51], v[144:147], v[80:95]
    ds_read_b128 v[140:143], v25 offset:0
    ds_read_b128 v[144:147], v25 offset:4096
    ds_read_b64_tr_b16 v[48:49], v20 offset:19456
    ds_read_b64_tr_b16 v[50:51], v20 offset:19968
    s_waitcnt lgkmcnt(4)
    v_mfma_f32_32x32x16_bf16 v[64:79], v[44:47], v[132:135], v[64:79]
    v_mfma_f32_32x32x16_bf16 v[80:95], v[44:47], v[136:139], v[80:95]
    s_waitcnt lgkmcnt(0)
    v_mfma_f32_32x32x16_bf16 v[64:79], v[48:51], v[140:143], v[64:79]
    v_mfma_f32_32x32x16_bf16 v[80:95], v[48:51], v[144:147], v[80:95]
    s_waitcnt vmcnt(18)
    s_barrier
    s_add_u32 m0, s36, 0x6000
    s_nop 0
    buffer_load_dwordx4 v129, s[12:15], s40 offen lds
    s_add_u32 s40, s40, 128
    s_add_u32 m0, s36, 0x7000
    s_nop 0
    buffer_load_dwordx4 v129, s[12:15], s41 offen lds
    s_add_u32 s41, s41, 128
    s_add_u32 m0, s36, 0x8000
    s_nop 0
    buffer_load_dwordx4 v129, s[12:15], s42 offen lds
    s_add_u32 s42, s42, 128
    s_add_u32 m0, s36, 0x9000
    s_nop 0
    buffer_load_dwordx4 v129, s[12:15], s43 offen lds
    s_add_u32 s43, s43, 128
    s_add_u32 m0, s37, 0xa000
    s_nop 0
    buffer_load_dwordx4 v128, s[16:19], s44 offen lds
    s_add_u32 s44, s44, s46
    s_add_u32 m0, s37, 0xa400
    s_nop 0
    buffer_load_dwordx4 v128, s[16:19], s45 offen lds
    s_add_u32 s45, s45, s46
    ds_read_b128 v[132:135], v28 offset:0
    ds_read_b128 v[136:139], v28 offset:4096
    ds_read_b64_tr_b16 v[44:45], v26 offset:16384
    ds_read_b64_tr_b16 v[46:47], v26 offset:16896
    ds_read_b128 v[140:143], v29 offset:0
    ds_read_b128 v[144:147], v29 offset:4096
    ds_read_b64_tr_b16 v[48:49], v26 offset:17408
    ds_read_b64_tr_b16 v[50:51], v26 offset:17920
    s_waitcnt lgkmcnt(4)
    v_mfma_f32_32x32x16_bf16 v[64:79], v[44:47], v[132:135], v[64:79]
    v_mfma_f32_32x32x16_bf16 v[80:95], v[44:47], v[136:139], v[80:95]
    ds_read_b128 v[132:135], v30 offset:0
    ds_read_b128 v[136:139], v30 offset:4096
    ds_read_b64_tr_b16 v[44:45], v26 offset:18432
    ds_read_b64_tr_b16 v[46:47], v26 offset:18944
    s_waitcnt lgkmcnt(4)
    v_mfma_f32_32x32x16_bf16 v[64:79], v[48:51], v[140:143], v[64:79]
    v_mfma_f32_32x32x16_bf16 v[80:95], v[48:51], v[144:147], v[80:95]
    ds_read_b128 v[140:143], v31 offset:0
    ds_read_b128 v[144:147], v31 offset:4096
    ds_read_b64_tr_b16 v[48:49], v26 offset:19456
    ds_read_b64_tr_b16 v[50:51], v26 offset:19968
    s_waitcnt lgkmcnt(4)
    v_mfma_f32_32x32x16_bf16 v[64:79], v[44:47], v[132:135], v[64:79]
    v_mfma_f32_32x32x16_bf16 v[80:95], v[44:47], v[136:139], v[80:95]
    s_waitcnt lgkmcnt(0)
    v_mfma_f32_32x32x16_bf16 v[64:79], v[48:51], v[140:143], v[64:79]
    v_mfma_f32_32x32x16_bf16 v[80:95], v[48:51], v[144:147], v[80:95]
    s_waitcnt vmcnt(18)
    s_barrier
    s_add_u32 m0, s36, 0xc000
    s_nop 0
    buffer_load_dwordx4 v129, s[12:15], s40 offen lds
    s_add_u32 s40, s40, 128
    s_add_u32 m0, s36, 0xd000
    s_nop 0
    buffer_load_dwordx4 v129, s[12:15], s41 offen lds
    s_add_u32 s41, s41, 128
    s_add_u32 m0, s36, 0xe000
    s_nop 0
    buffer_load_dwordx4 v129, s[12:15], s42 offen lds
    s_add_u32 s42, s42, 128
    s_add_u32 m0, s36, 0xf000
    s_nop 0
    buffer_load_dwordx4 v129, s[12:15], s43 offen lds
    s_add_u32 s43, s43, 128
    s_add_u32 m0, s37, 0x10000
    s_nop 0
    buffer_load_dwordx4 v128, s[16:19], s44 offen lds
    s_add_u32 s44, s44, s46
    s_add_u32 m0, s37, 0x10400
    s_nop 0
    buffer_load_dwordx4 v128, s[16:19], s45 offen lds
    s_add_u32 s45, s45, s46
    ds_read_b128 v[132:135], v34 offset:0
    ds_read_b128 v[136:139], v34 offset:4096
    ds_read_b64_tr_b16 v[44:45], v32 offset:16384
    ds_read_b64_tr_b16 v[46:47], v32 offset:16896
    ds_read_b128 v[140:143], v35 offset:0
    ds_read_b128 v[144:147], v35 offset:4096
    ds_read_b64_tr_b16 v[48:49], v32 offset:17408
    ds_read_b64_tr_b16 v[50:51], v32 offset:17920
    s_waitcnt lgkmcnt(4)
    v_mfma_f32_32x32x16_bf16 v[64:79], v[44:47], v[132:135], v[64:79]
    v_mfma_f32_32x32x16_bf16 v[80:95], v[44:47], v[136:139], v[80:95]
    ds_read_b128 v[132:135], v36 offset:0
    ds_read_b128 v[136:139], v36 offset:4096
    ds_read_b64_tr_b16 v[44:45], v32 offset:18432
    ds_read_b64_tr_b16 v[46:47], v32 offset:18944
    s_waitcnt lgkmcnt(4)
    v_mfma_f32_32x32x16_bf16 v[64:79], v[48:51], v[140:143], v[64:79]
    v_mfma_f32_32x32x16_bf16 v[80:95], v[48:51], v[144:147], v[80:95]
    ds_read_b128 v[140:143], v37 offset:0
    ds_read_b128 v[144:147], v37 offset:4096
    ds_read_b64_tr_b16 v[48:49], v32 offset:19456
    ds_read_b64_tr_b16 v[50:51], v32 offset:19968
    s_waitcnt lgkmcnt(4)
    v_mfma_f32_32x32x16_bf16 v[64:79], v[44:47], v[132:135], v[64:79]
    v_mfma_f32_32x32x16_bf16 v[80:95], v[44:47], v[136:139], v[80:95]
    s_waitcnt lgkmcnt(0)
    v_mfma_f32_32x32x16_bf16 v[64:79], v[48:51], v[140:143], v[64:79]
    v_mfma_f32_32x32x16_bf16 v[80:95], v[48:51], v[144:147], v[80:95]
    s_waitcnt vmcnt(18)
    s_barrier
    s_add_u32 m0, s36, 0x12000
    s_nop 0
    buffer_load_dwordx4 v129, s[12:15], s40 offen lds
    s_add_u32 s40, s40, 128
    s_add_u32 m0, s36, 0x13000
    s_nop 0
    buffer_load_dwordx4 v129, s[12:15], s41 offen lds
    s_add_u32 s41, s41, 128
    s_add_u32 m0, s36, 0x14000
    s_nop 0
    buffer_load_dwordx4 v129, s[12:15], s42 offen lds
    s_add_u32 s42, s42, 128
    s_add_u32 m0, s36, 0x15000
    s_nop 0
    buffer_load_dwordx4 v129, s[12:15], s43 offen lds
    s_add_u32 s43, s43, 128
    s_add_u32 m0, s37, 0x16000
    s_nop 0
    buffer_load_dwordx4 v128, s[16:19], s44 offen lds
    s_add_u32 s44, s44, s46
    s_add_u32 m0, s37, 0x16400
    s_nop 0
    buffer_load_dwordx4 v128, s[16:19], s45 offen lds
    s_add_u32 s45, s45, s46
    ds_read_b128 v[132:135], v40 offset:0
    ds_read_b128 v[136:139], v40 offset:4096
    ds_read_b64_tr_b16 v[44:45], v38 offset:16384
    ds_read_b64_tr_b16 v[46:47], v38 offset:16896
    ds_read_b128 v[140:143], v41 offset:0
    ds_read_b128 v[144:147], v41 offset:4096
    ds_read_b64_tr_b16 v[48:49], v38 offset:17408
    ds_read_b64_tr_b16 v[50:51], v38 offset:17920
    s_waitcnt lgkmcnt(4)
    v_mfma_f32_32x32x16_bf16 v[64:79], v[44:47], v[132:135], v[64:79]
    v_mfma_f32_32x32x16_bf16 v[80:95], v[44:47], v[136:139], v[80:95]
    ds_read_b128 v[132:135], v42 offset:0
    ds_read_b128 v[136:139], v42 offset:4096
    ds_read_b64_tr_b16 v[44:45], v38 offset:18432
    ds_read_b64_tr_b16 v[46:47], v38 offset:18944
    s_waitcnt lgkmcnt(4)
    v_mfma_f32_32x32x16_bf16 v[64:79], v[48:51], v[140:143], v[64:79]
    v_mfma_f32_32x32x16_bf16 v[80:95], v[48:51], v[144:147], v[80:95]
    ds_read_b128 v[140:143], v43 offset:0
    ds_read_b128 v[144:147], v43 offset:4096
    ds_read_b64_tr_b16 v[48:49], v38 offset:19456
    ds_read_b64_tr_b16 v[50:51], v38 offset:19968
    s_waitcnt lgkmcnt(4)
    v_mfma_f32_32x32x16_bf16 v[64:79], v[44:47], v[132:135], v[64:79]
    v_mfma_f32_32x32x16_bf16 v[80:95], v[44:47], v[136:139], v[80:95]
    s_waitcnt lgkmcnt(0)
    v_mfma_f32_32x32x16_bf16 v[64:79], v[48:51], v[140:143], v[64:79]
    v_mfma_f32_32x32x16_bf16 v[80:95], v[48:51], v[144:147], v[80:95]
    s_waitcnt vmcnt(18)
    s_barrier
    s_add_u32 m0, s36, 0x18000
    s_nop 0
    buffer_load_dwordx4 v129, s[12:15], s40 offen lds
    s_add_u32 s40, s40, 128
    s_add_u32 m0, s36, 0x19000
    s_nop 0
    buffer_load_dwordx4 v129, s[12:15], s41 offen lds
    s_add_u32 s41, s41, 128
    s_add_u32 m0, s36, 0x1a000
    s_nop 0
    buffer_load_dwordx4 v129, s[12:15], s42 offen lds
    s_add_u32 s42, s42, 128
    s_add_u32 m0, s36, 0x1b000
    s_nop 0
    buffer_load_dwordx4 v129, s[12:15], s43 offen lds
    s_add_u32 s43, s43, 128
    s_add_u32 m0, s37, 0x1c000
    s_nop 0
    buffer_load_dwordx4 v128, s[16:19], s44 offen lds
    s_add_u32 s44, s44, s46
    s_add_u32 m0, s37, 0x1c400
    s_nop 0
    buffer_load_dwordx4 v128, s[16:19], s45 offen lds
    s_add_u32 s45, s45, s46
    ds_read_b128 v[132:135], v16 offset:0
    ds_read_b128 v[136:139], v16 offset:4096
    ds_read_b64_tr_b16 v[44:45], v14 offset:16384
    ds_read_b64_tr_b16 v[46:47], v14 offset:16896
    ds_read_b128 v[140:143], v17 offset:0
    ds_read_b128 v[144:147], v17 offset:4096
    ds_read_b64_tr_b16 v[48:49], v14 offset:17408
    ds_read_b64_tr_b16 v[50:51], v14 offset:17920
    s_waitcnt lgkmcnt(4)
    v_mfma_f32_32x32x16_bf16 v[64:79], v[44:47], v[132:135], v[64:79]
    v_mfma_f32_32x32x16_bf16 v[80:95], v[44:47], v[136:139], v[80:95]
    ds_read_b128 v[132:135], v18 offset:0
    ds_read_b128 v[136:139], v18 offset:4096
    ds_read_b64_tr_b16 v[44:45], v14 offset:18432
    ds_read_b64_tr_b16 v[46:47], v14 offset:18944
    s_waitcnt lgkmcnt(4)
    v_mfma_f32_32x32x16_bf16 v[64:79], v[48:51], v[140:143], v[64:79]
    v_mfma_f32_32x32x16_bf16 v[80:95], v[48:51], v[144:147], v[80:95]
    ds_read_b128 v[140:143], v19 offset:0
    ds_read_b128 v[144:147], v19 offset:4096
    ds_read_b64_tr_b16 v[48:49], v14 offset:19456
    ds_read_b64_tr_b16 v[50:51], v14 offset:19968
    s_waitcnt lgkmcnt(4)
    v_mfma_f32_32x32x16_bf16 v[64:79], v[44:47], v[132:135], v[64:79]
    v_mfma_f32_32x32x16_bf16 v[80:95], v[44:47], v[136:139], v[80:95]
    s_waitcnt lgkmcnt(0)
    v_mfma_f32_32x32x16_bf16 v[64:79], v[48:51], v[140:143], v[64:79]
    v_mfma_f32_32x32x16_bf16 v[80:95], v[48:51], v[144:147], v[80:95]
    s_waitcnt vmcnt(18)
    s_barrier
    s_add_u32 m0, s36, 0x0
    s_nop 0
    buffer_load_dwordx4 v130, s[56:59], s64 offen lds
    s_add_u32 s64, s64, 128
    s_add_u32 m0, s36, 0x1000
    s_nop 0
    buffer_load_dwordx4 v130, s[56:59], s65 offen lds
    s_add_u32 s65, s65, 128
    s_add_u32 m0, s36, 0x2000
    s_nop 0
    buffer_load_dwordx4 v130, s[56:59], s66 offen lds
    s_add_u32 s66, s66, 128
    s_add_u32 m0, s36, 0x3000
    s_nop 0
    buffer_load_dwordx4 v130, s[56:59], s67 offen lds
    s_add_u32 s67, s67, 128
    s_add_u32 m0, s37, 0x4000
    s_nop 0
    buffer_load_dwordx4 v128, s[60:63], s68 offen lds
    s_add_u32 s68, s68, s46
    s_add_u32 m0, s37, 0x4400
    s_nop 0
    buffer_load_dwordx4 v128, s[60:63], s69 offen lds
    s_add_u32 s69, s69, s46
    ds_read_b128 v[132:135], v22 offset:0
    ds_read_b128 v[136:139], v22 offset:4096
    ds_read_b64_tr_b16 v[44:45], v20 offset:16384
    ds_read_b64_tr_b16 v[46:47], v20 offset:16896
    ds_read_b128 v[140:143], v23 offset:0
    ds_read_b128 v[144:147], v23 offset:4096
    ds_read_b64_tr_b16 v[48:49], v20 offset:17408
    ds_read_b64_tr_b16 v[50:51], v20 offset:17920
    s_waitcnt lgkmcnt(4)
    v_mfma_f32_32x32x16_bf16 v[64:79], v[44:47], v[132:135], v[64:79]
    v_mfma_f32_32x32x16_bf16 v[80:95], v[44:47], v[136:139], v[80:95]
    ds_read_b128 v[132:135], v24 offset:0
    ds_read_b128 v[136:139], v24 offset:4096
    ds_read_b64_tr_b16 v[44:45], v20 offset:18432
    ds_read_b64_tr_b16 v[46:47], v20 offset:18944
    s_waitcnt lgkmcnt(4)
    v_mfma_f32_32x32x16_bf16 v[64:79], v[48:51], v[140:143], v[64:79]
    v_mfma_f32_32x32x16_bf16 v[80:95], v[48:51], v[144:147], v[80:95]
    ds_read_b128 v[140:143], v25 offset:0
    ds_read_b128 v[144:147], v25 offset:4096
    ds_read_b64_tr_b16 v[48:49], v20 offset:19456
    ds_read_b64_tr_b16 v[50:51], v20 offset:19968
    s_waitcnt lgkmcnt(4)
    v_mfma_f32_32x32x16_bf16 v[64:79], v[44:47], v[132:135], v[64:79]
    v_mfma_f32_32x32x16_bf16 v[80:95], v[44:47], v[136:139], v[80:95]
    s_waitcnt lgkmcnt(0)
    v_mfma_f32_32x32x16_bf16 v[64:79], v[48:51], v[140:143], v[64:79]
    v_mfma_f32_32x32x16_bf16 v[80:95], v[48:51], v[144:147], v[80:95]
    s_waitcnt vmcnt(18)
    s_barrier
    s_add_u32 m0, s36, 0x6000
    s_nop 0
    buffer_load_dwordx4 v130, s[56:59], s64 offen lds
    s_add_u32 s64, s64, 128
    s_add_u32 m0, s36, 0x7000
    s_nop 0
    buffer_load_dwordx4 v130, s[56:59], s65 offen lds
    s_add_u32 s65, s65, 128
    s_add_u32 m0, s36, 0x8000
    s_nop 0
    buffer_load_dwordx4 v130, s[56:59], s66 offen lds
    s_add_u32 s66, s66, 128
    s_add_u32 m0, s36, 0x9000
    s_nop 0
    buffer_load_dwordx4 v130, s[56:59], s67 offen lds
    s_add_u32 s67, s67, 128
    s_add_u32 m0, s37, 0xa000
    s_nop 0
    buffer_load_dwordx4 v128, s[60:63], s68 offen lds
    s_add_u32 s68, s68, s46
    s_add_u32 m0, s37, 0xa400
    s_nop 0
    buffer_load_dwordx4 v128, s[60:63], s69 offen lds
    s_add_u32 s69, s69, s46
    ds_read_b128 v[132:135], v28 offset:0
    ds_read_b128 v[136:139], v28 offset:4096
    ds_read_b64_tr_b16 v[44:45], v26 offset:16384
    ds_read_b64_tr_b16 v[46:47], v26 offset:16896
    ds_read_b128 v[140:143], v29 offset:0
    ds_read_b128 v[144:147], v29 offset:4096
    ds_read_b64_tr_b16 v[48:49], v26 offset:17408
    ds_read_b64_tr_b16 v[50:51], v26 offset:17920
    s_waitcnt lgkmcnt(4)
    v_mfma_f32_32x32x16_bf16 v[64:79], v[44:47], v[132:135], v[64:79]
    v_mfma_f32_32x32x16_bf16 v[80:95], v[44:47], v[136:139], v[80:95]
    ds_read_b128 v[132:135], v30 offset:0
    ds_read_b128 v[136:139], v30 offset:4096
    ds_read_b64_tr_b16 v[44:45], v26 offset:18432
    ds_read_b64_tr_b16 v[46:47], v26 offset:18944
    s_waitcnt lgkmcnt(4)
    v_mfma_f32_32x32x16_bf16 v[64:79], v[48:51], v[140:143], v[64:79]
    v_mfma_f32_32x32x16_bf16 v[80:95], v[48:51], v[144:147], v[80:95]
    ds_read_b128 v[140:143], v31 offset:0
    ds_read_b128 v[144:147], v31 offset:4096
    ds_read_b64_tr_b16 v[48:49], v26 offset:19456
    ds_read_b64_tr_b16 v[50:51], v26 offset:19968
    s_waitcnt lgkmcnt(4)
    v_mfma_f32_32x32x16_bf16 v[64:79], v[44:47], v[132:135], v[64:79]
    v_mfma_f32_32x32x16_bf16 v[80:95], v[44:47], v[136:139], v[80:95]
    s_waitcnt lgkmcnt(0)
    v_mfma_f32_32x32x16_bf16 v[64:79], v[48:51], v[140:143], v[64:79]
    v_mfma_f32_32x32x16_bf16 v[80:95], v[48:51], v[144:147], v[80:95]
    s_waitcnt vmcnt(18)
    s_barrier
    s_add_u32 m0, s36, 0xc000
    s_nop 0
    buffer_load_dwordx4 v130, s[56:59], s64 offen lds
    s_add_u32 s64, s64, 128
    s_add_u32 m0, s36, 0xd000
    s_nop 0
    buffer_load_dwordx4 v130, s[56:59], s65 offen lds
    s_add_u32 s65, s65, 128
    s_add_u32 m0, s36, 0xe000
    s_nop 0
    buffer_load_dwordx4 v130, s[56:59], s66 offen lds
    s_add_u32 s66, s66, 128
    s_add_u32 m0, s36, 0xf000
    s_nop 0
    buffer_load_dwordx4 v130, s[56:59], s67 offen lds
    s_add_u32 s67, s67, 128
    s_add_u32 m0, s37, 0x10000
    s_nop 0
    buffer_load_dwordx4 v128, s[60:63], s68 offen lds
    s_add_u32 s68, s68, s46
    s_add_u32 m0, s37, 0x10400
    s_nop 0
    buffer_load_dwordx4 v128, s[60:63], s69 offen lds
    s_add_u32 s69, s69, s46
    ds_read_b128 v[132:135], v34 offset:0
    ds_read_b128 v[136:139], v34 offset:4096
    ds_read_b64_tr_b16 v[44:45], v32 offset:16384
    ds_read_b64_tr_b16 v[46:47], v32 offset:16896
    ds_read_b128 v[140:143], v35 offset:0
    ds_read_b128 v[144:147], v35 offset:4096
    ds_read_b64_tr_b16 v[48:49], v32 offset:17408
    ds_read_b64_tr_b16 v[50:51], v32 offset:17920
    s_waitcnt lgkmcnt(4)
    v_mfma_f32_32x32x16_bf16 v[64:79], v[44:47], v[132:135], v[64:79]
    v_mfma_f32_32x32x16_bf16 v[80:95], v[44:47], v[136:139], v[80:95]
    ds_read_b128 v[132:135], v36 offset:0
    ds_read_b128 v[136:139], v36 offset:4096
    ds_read_b64_tr_b16 v[44:45], v32 offset:18432
    ds_read_b64_tr_b16 v[46:47], v32 offset:18944
    s_waitcnt lgkmcnt(4)
    v_mfma_f32_32x32x16_bf16 v[64:79], v[48:51], v[140:143], v[64:79]
    v_mfma_f32_32x32x16_bf16 v[80:95], v[48:51], v[144:147], v[80:95]
    ds_read_b128 v[140:143], v37 offset:0
    ds_read_b128 v[144:147], v37 offset:4096
    ds_read_b64_tr_b16 v[48:49], v32 offset:19456
    ds_read_b64_tr_b16 v[50:51], v32 offset:19968
    s_waitcnt lgkmcnt(4)
    v_mfma_f32_32x32x16_bf16 v[64:79], v[44:47], v[132:135], v[64:79]
    v_mfma_f32_32x32x16_bf16 v[80:95], v[44:47], v[136:139], v[80:95]
    s_waitcnt lgkmcnt(0)
    v_mfma_f32_32x32x16_bf16 v[64:79], v[48:51], v[140:143], v[64:79]
    v_mfma_f32_32x32x16_bf16 v[80:95], v[48:51], v[144:147], v[80:95]
    s_waitcnt vmcnt(18)
    s_barrier
    s_add_u32 m0, s36, 0x12000
    s_nop 0
    buffer_load_dwordx4 v130, s[56:59], s64 offen lds
    s_add_u32 s64, s64, 128
    s_add_u32 m0, s36, 0x13000
    s_nop 0
    buffer_load_dwordx4 v130, s[56:59], s65 offen lds
    s_add_u32 s65, s65, 128
    s_add_u32 m0, s36, 0x14000
    s_nop 0
    buffer_load_dwordx4 v130, s[56:59], s66 offen lds
    s_add_u32 s66, s66, 128
    s_add_u32 m0, s36, 0x15000
    s_nop 0
    buffer_load_dwordx4 v130, s[56:59], s67 offen lds
    s_add_u32 s67, s67, 128
    s_add_u32 m0, s37, 0x16000
    s_nop 0
    buffer_load_dwordx4 v128, s[60:63], s68 offen lds
    s_add_u32 s68, s68, s46
    s_add_u32 m0, s37, 0x16400
    s_nop 0
    buffer_load_dwordx4 v128, s[60:63], s69 offen lds
    s_add_u32 s69, s69, s46
    ds_read_b128 v[132:135], v40 offset:0
    ds_read_b128 v[136:139], v40 offset:4096
    ds_read_b64_tr_b16 v[44:45], v38 offset:16384
    ds_read_b64_tr_b16 v[46:47], v38 offset:16896
    ds_read_b128 v[140:143], v41 offset:0
    ds_read_b128 v[144:147], v41 offset:4096
    ds_read_b64_tr_b16 v[48:49], v38 offset:17408
    ds_read_b64_tr_b16 v[50:51], v38 offset:17920
    s_waitcnt lgkmcnt(4)
    v_mfma_f32_32x32x16_bf16 v[64:79], v[44:47], v[132:135], v[64:79]
    v_mfma_f32_32x32x16_bf16 v[80:95], v[44:47], v[136:139], v[80:95]
    ds_read_b128 v[132:135], v42 offset:0
    ds_read_b128 v[136:139], v42 offset:4096
    ds_read_b64_tr_b16 v[44:45], v38 offset:18432
    ds_read_b64_tr_b16 v[46:47], v38 offset:18944
    s_waitcnt lgkmcnt(4)
    v_mfma_f32_32x32x16_bf16 v[64:79], v[48:51], v[140:143], v[64:79]
    v_mfma_f32_32x32x16_bf16 v[80:95], v[48:51], v[144:147], v[80:95]
    ds_read_b128 v[140:143], v43 offset:0
    ds_read_b128 v[144:147], v43 offset:4096
    ds_read_b64_tr_b16 v[48:49], v38 offset:19456
    ds_read_b64_tr_b16 v[50:51], v38 offset:19968
    s_waitcnt lgkmcnt(4)
    v_mfma_f32_32x32x16_bf16 v[64:79], v[44:47], v[132:135], v[64:79]
    v_mfma_f32_32x32x16_bf16 v[80:95], v[44:47], v[136:139], v[80:95]
    s_waitcnt lgkmcnt(0)
    v_mfma_f32_32x32x16_bf16 v[64:79], v[48:51], v[140:143], v[64:79]
    v_mfma_f32_32x32x16_bf16 v[80:95], v[48:51], v[144:147], v[80:95]
    s_waitcnt vmcnt(18)
    s_barrier
    s_add_u32 m0, s36, 0x18000
    s_nop 0
    buffer_load_dwordx4 v130, s[56:59], s64 offen lds
    s_add_u32 s64, s64, 128
    s_add_u32 m0, s36, 0x19000
    s_nop 0
    buffer_load_dwordx4 v130, s[56:59], s65 offen lds
    s_add_u32 s65, s65, 128
    s_add_u32 m0, s36, 0x1a000
    s_nop 0
    buffer_load_dwordx4 v130, s[56:59], s66 offen lds
    s_add_u32 s66, s66, 128
    s_add_u32 m0, s36, 0x1b000
    s_nop 0
    buffer_load_dwordx4 v130, s[56:59], s67 offen lds
    s_add_u32 s67, s67, 128
    s_add_u32 m0, s37, 0x1c000
    s_nop 0
    buffer_load_dwordx4 v128, s[60:63], s68 offen lds
    s_add_u32 s68, s68, s46
    s_add_u32 m0, s37, 0x1c400
    s_nop 0
    buffer_load_dwordx4 v128, s[60:63], s69 offen lds
    s_add_u32 s69, s69, s46
    ds_read_b128 v[132:135], v16 offset:0
    ds_read_b128 v[136:139], v16 offset:4096
    ds_read_b64_tr_b16 v[44:45], v14 offset:16384
    ds_read_b64_tr_b16 v[46:47], v14 offset:16896
    ds_read_b128 v[140:143], v17 offset:0
    ds_read_b128 v[144:147], v17 offset:4096
    ds_read_b64_tr_b16 v[48:49], v14 offset:17408
    ds_read_b64_tr_b16 v[50:51], v14 offset:17920
    s_waitcnt lgkmcnt(4)
    v_mfma_f32_32x32x16_bf16 v[96:111], v[44:47], v[132:135], 0
    v_mfma_f32_32x32x16_bf16 v[112:127], v[44:47], v[136:139], 0
    ds_read_b128 v[132:135], v18 offset:0
    ds_read_b128 v[136:139], v18 offset:4096
    ds_read_b64_tr_b16 v[44:45], v14 offset:18432
    ds_read_b64_tr_b16 v[46:47], v14 offset:18944
    s_waitcnt lgkmcnt(4)
    v_mfma_f32_32x32x16_bf16 v[96:111], v[48:51], v[140:143], v[96:111]
    v_mfma_f32_32x32x16_bf16 v[112:127], v[48:51], v[144:147], v[112:127]
    ds_read_b128 v[140:143], v19 offset:0
    ds_read_b128 v[144:147], v19 offset:4096
    ds_read_b64_tr_b16 v[48:49], v14 offset:19456
    ds_read_b64_tr_b16 v[50:51], v14 offset:19968
    s_waitcnt lgkmcnt(4)
    v_mfma_f32_32x32x16_bf16 v[96:111], v[44:47], v[132:135], v[96:111]
    v_mfma_f32_32x32x16_bf16 v[112:127], v[44:47], v[136:139], v[112:127]
    s_waitcnt lgkmcnt(0)
    v_mfma_f32_32x32x16_bf16 v[96:111], v[48:51], v[140:143], v[96:111]
    v_mfma_f32_32x32x16_bf16 v[112:127], v[48:51], v[144:147], v[112:127]
    s_waitcnt vmcnt(18)
    s_barrier
    s_add_u32 m0, s36, 0x0
    s_nop 0
    buffer_load_dwordx4 v130, s[56:59], s64 offen lds
    s_add_u32 s64, s64, 128
    s_add_u32 m0, s36, 0x1000
    s_nop 0
    buffer_load_dwordx4 v130, s[56:59], s65 offen lds
    s_add_u32 s65, s65, 128
    s_add_u32 m0, s36, 0x2000
    s_nop 0
    buffer_load_dwordx4 v130, s[56:59], s66 offen lds
    s_add_u32 s66, s66, 128
    s_add_u32 m0, s36, 0x3000
    s_nop 0
    buffer_load_dwordx4 v130, s[56:59], s67 offen lds
    s_add_u32 s67, s67, 128
    s_add_u32 m0, s37, 0x4000
    s_nop 0
    buffer_load_dwordx4 v128, s[60:63], s68 offen lds
    s_add_u32 s68, s68, s46
    s_add_u32 m0, s37, 0x4400
    s_nop 0
    buffer_load_dwordx4 v128, s[60:63], s69 offen lds
    s_add_u32 s69, s69, s46
    ds_read_b128 v[132:135], v22 offset:0
    ds_read_b128 v[136:139], v22 offset:4096
    ds_read_b64_tr_b16 v[44:45], v20 offset:16384
    ds_read_b64_tr_b16 v[46:47], v20 offset:16896
    ds_read_b128 v[140:143], v23 offset:0
    ds_read_b128 v[144:147], v23 offset:4096
    ds_read_b64_tr_b16 v[48:49], v20 offset:17408
    ds_read_b64_tr_b16 v[50:51], v20 offset:17920
    s_waitcnt lgkmcnt(4)
    v_mfma_f32_32x32x16_bf16 v[96:111], v[44:47], v[132:135], v[96:111]
    v_mfma_f32_32x32x16_bf16 v[112:127], v[44:47], v[136:139], v[112:127]
    ds_read_b128 v[132:135], v24 offset:0
    ds_read_b128 v[136:139], v24 offset:4096
    ds_read_b64_tr_b16 v[44:45], v20 offset:18432
    ds_read_b64_tr_b16 v[46:47], v20 offset:18944
    s_waitcnt lgkmcnt(4)
    v_mfma_f32_32x32x16_bf16 v[96:111], v[48:51], v[140:143], v[96:111]
    v_mfma_f32_32x32x16_bf16 v[112:127], v[48:51], v[144:147], v[112:127]
    ds_read_b128 v[140:143], v25 offset:0
    ds_read_b128 v[144:147], v25 offset:4096
    ds_read_b64_tr_b16 v[48:49], v20 offset:19456
    ds_read_b64_tr_b16 v[50:51], v20 offset:19968
    s_waitcnt lgkmcnt(4)
    v_mfma_f32_32x32x16_bf16 v[96:111], v[44:47], v[132:135], v[96:111]
    v_mfma_f32_32x32x16_bf16 v[112:127], v[44:47], v[136:139], v[112:127]
    s_waitcnt lgkmcnt(0)
    v_mfma_f32_32x32x16_bf16 v[96:111], v[48:51], v[140:143], v[96:111]
    v_mfma_f32_32x32x16_bf16 v[112:127], v[48:51], v[144:147], v[112:127]
    s_waitcnt vmcnt(18)
    s_barrier
    s_add_u32 m0, s36, 0x6000
    s_nop 0
    buffer_load_dwordx4 v130, s[56:59], s64 offen lds
    s_add_u32 s64, s64, 128
    s_add_u32 m0, s36, 0x7000
    s_nop 0
    buffer_load_dwordx4 v130, s[56:59], s65 offen lds
    s_add_u32 s65, s65, 128
    s_add_u32 m0, s36, 0x8000
    s_nop 0
    buffer_load_dwordx4 v130, s[56:59], s66 offen lds
    s_add_u32 s66, s66, 128
    s_add_u32 m0, s36, 0x9000
    s_nop 0
    buffer_load_dwordx4 v130, s[56:59], s67 offen lds
    s_add_u32 s67, s67, 128
    s_add_u32 m0, s37, 0xa000
    s_nop 0
    buffer_load_dwordx4 v128, s[60:63], s68 offen lds
    s_add_u32 s68, s68, s46
    s_add_u32 m0, s37, 0xa400
    s_nop 0
    buffer_load_dwordx4 v128, s[60:63], s69 offen lds
    s_add_u32 s69, s69, s46
    ds_read_b128 v[132:135], v28 offset:0
    ds_read_b128 v[136:139], v28 offset:4096
    ds_read_b64_tr_b16 v[44:45], v26 offset:16384
    ds_read_b64_tr_b16 v[46:47], v26 offset:16896
    ds_read_b128 v[140:143], v29 offset:0
    ds_read_b128 v[144:147], v29 offset:4096
    ds_read_b64_tr_b16 v[48:49], v26 offset:17408
    ds_read_b64_tr_b16 v[50:51], v26 offset:17920
    s_waitcnt lgkmcnt(4)
    v_mfma_f32_32x32x16_bf16 v[96:111], v[44:47], v[132:135], v[96:111]
    v_mfma_f32_32x32x16_bf16 v[112:127], v[44:47], v[136:139], v[112:127]
    ds_read_b128 v[132:135], v30 offset:0
    ds_read_b128 v[136:139], v30 offset:4096
    ds_read_b64_tr_b16 v[44:45], v26 offset:18432
    ds_read_b64_tr_b16 v[46:47], v26 offset:18944
    s_waitcnt lgkmcnt(4)
    v_mfma_f32_32x32x16_bf16 v[96:111], v[48:51], v[140:143], v[96:111]
    v_mfma_f32_32x32x16_bf16 v[112:127], v[48:51], v[144:147], v[112:127]
    ds_read_b128 v[140:143], v31 offset:0
    ds_read_b128 v[144:147], v31 offset:4096
    ds_read_b64_tr_b16 v[48:49], v26 offset:19456
    ds_read_b64_tr_b16 v[50:51], v26 offset:19968
    s_waitcnt lgkmcnt(4)
    v_mfma_f32_32x32x16_bf16 v[96:111], v[44:47], v[132:135], v[96:111]
    v_mfma_f32_32x32x16_bf16 v[112:127], v[44:47], v[136:139], v[112:127]
    s_waitcnt lgkmcnt(0)
    v_mfma_f32_32x32x16_bf16 v[96:111], v[48:51], v[140:143], v[96:111]
    v_mfma_f32_32x32x16_bf16 v[112:127], v[48:51], v[144:147], v[112:127]
    s_waitcnt vmcnt(18)
    s_barrier
    s_add_u32 m0, s36, 0xc000
    s_nop 0
    buffer_load_dwordx4 v130, s[56:59], s64 offen lds
    s_add_u32 s64, s64, 128
    s_add_u32 m0, s36, 0xd000
    s_nop 0
    buffer_load_dwordx4 v130, s[56:59], s65 offen lds
    s_add_u32 s65, s65, 128
    s_add_u32 m0, s36, 0xe000
    s_nop 0
    buffer_load_dwordx4 v130, s[56:59], s66 offen lds
    s_add_u32 s66, s66, 128
    s_add_u32 m0, s36, 0xf000
    s_nop 0
    buffer_load_dwordx4 v130, s[56:59], s67 offen lds
    s_add_u32 s67, s67, 128
    s_add_u32 m0, s37, 0x10000
    s_nop 0
    buffer_load_dwordx4 v128, s[60:63], s68 offen lds
    s_add_u32 s68, s68, s46
    s_add_u32 m0, s37, 0x10400
    s_nop 0
    buffer_load_dwordx4 v128, s[60:63], s69 offen lds
    s_add_u32 s69, s69, s46
    ds_read_b128 v[132:135], v34 offset:0
    ds_read_b128 v[136:139], v34 offset:4096
    ds_read_b64_tr_b16 v[44:45], v32 offset:16384
    ds_read_b64_tr_b16 v[46:47], v32 offset:16896
    ds_read_b128 v[140:143], v35 offset:0
    ds_read_b128 v[144:147], v35 offset:4096
    ds_read_b64_tr_b16 v[48:49], v32 offset:17408
    ds_read_b64_tr_b16 v[50:51], v32 offset:17920
    s_waitcnt lgkmcnt(4)
    v_mfma_f32_32x32x16_bf16 v[96:111], v[44:47], v[132:135], v[96:111]
    v_mfma_f32_32x32x16_bf16 v[112:127], v[44:47], v[136:139], v[112:127]
    ds_read_b128 v[132:135], v36 offset:0
    ds_read_b128 v[136:139], v36 offset:4096
    ds_read_b64_tr_b16 v[44:45], v32 offset:18432
    ds_read_b64_tr_b16 v[46:47], v32 offset:18944
    s_waitcnt lgkmcnt(4)
    v_mfma_f32_32x32x16_bf16 v[96:111], v[48:51], v[140:143], v[96:111]
    v_mfma_f32_32x32x16_bf16 v[112:127], v[48:51], v[144:147], v[112:127]
    ds_read_b128 v[140:143], v37 offset:0
    ds_read_b128 v[144:147], v37 offset:4096
    ds_read_b64_tr_b16 v[48:49], v32 offset:19456
    ds_read_b64_tr_b16 v[50:51], v32 offset:19968
    s_waitcnt lgkmcnt(4)
    v_mfma_f32_32x32x16_bf16 v[96:111], v[44:47], v[132:135], v[96:111]
    v_mfma_f32_32x32x16_bf16 v[112:127], v[44:47], v[136:139], v[112:127]
    s_waitcnt lgkmcnt(0)
    v_mfma_f32_32x32x16_bf16 v[96:111], v[48:51], v[140:143], v[96:111]
    v_mfma_f32_32x32x16_bf16 v[112:127], v[48:51], v[144:147], v[112:127]
    s_waitcnt vmcnt(18)
    s_barrier
    s_add_u32 m0, s36, 0x12000
    s_nop 0
    buffer_load_dwordx4 v130, s[56:59], s64 offen lds
    s_add_u32 s64, s64, 128
    s_add_u32 m0, s36, 0x13000
    s_nop 0
    buffer_load_dwordx4 v130, s[56:59], s65 offen lds
    s_add_u32 s65, s65, 128
    s_add_u32 m0, s36, 0x14000
    s_nop 0
    buffer_load_dwordx4 v130, s[56:59], s66 offen lds
    s_add_u32 s66, s66, 128
    s_add_u32 m0, s36, 0x15000
    s_nop 0
    buffer_load_dwordx4 v130, s[56:59], s67 offen lds
    s_add_u32 s67, s67, 128
    s_add_u32 m0, s37, 0x16000
    s_nop 0
    buffer_load_dwordx4 v128, s[60:63], s68 offen lds
    s_add_u32 s68, s68, s46
    s_add_u32 m0, s37, 0x16400
    s_nop 0
    buffer_load_dwordx4 v128, s[60:63], s69 offen lds
    s_add_u32 s69, s69, s46
    ds_read_b128 v[132:135], v40 offset:0
    ds_read_b128 v[136:139], v40 offset:4096
    ds_read_b64_tr_b16 v[44:45], v38 offset:16384
    ds_read_b64_tr_b16 v[46:47], v38 offset:16896
    ds_read_b128 v[140:143], v41 offset:0
    ds_read_b128 v[144:147], v41 offset:4096
    ds_read_b64_tr_b16 v[48:49], v38 offset:17408
    ds_read_b64_tr_b16 v[50:51], v38 offset:17920
    s_waitcnt lgkmcnt(4)
    v_mfma_f32_32x32x16_bf16 v[96:111], v[44:47], v[132:135], v[96:111]
    v_mfma_f32_32x32x16_bf16 v[112:127], v[44:47], v[136:139], v[112:127]
    ds_read_b128 v[132:135], v42 offset:0
    ds_read_b128 v[136:139], v42 offset:4096
    ds_read_b64_tr_b16 v[44:45], v38 offset:18432
    ds_read_b64_tr_b16 v[46:47], v38 offset:18944
    s_waitcnt lgkmcnt(4)
    v_mfma_f32_32x32x16_bf16 v[96:111], v[48:51], v[140:143], v[96:111]
    v_mfma_f32_32x32x16_bf16 v[112:127], v[48:51], v[144:147], v[112:127]
    ds_read_b128 v[140:143], v43 offset:0
    ds_read_b128 v[144:147], v43 offset:4096
    ds_read_b64_tr_b16 v[48:49], v38 offset:19456
    ds_read_b64_tr_b16 v[50:51], v38 offset:19968
    s_waitcnt lgkmcnt(4)
    v_mfma_f32_32x32x16_bf16 v[96:111], v[44:47], v[132:135], v[96:111]
    v_mfma_f32_32x32x16_bf16 v[112:127], v[44:47], v[136:139], v[112:127]
    s_waitcnt lgkmcnt(0)
    v_mfma_f32_32x32x16_bf16 v[96:111], v[48:51], v[140:143], v[96:111]
    v_mfma_f32_32x32x16_bf16 v[112:127], v[48:51], v[144:147], v[112:127]
    s_waitcnt vmcnt(18)
    s_barrier
    s_add_u32 m0, s36, 0x18000
    s_nop 0
    buffer_load_dwordx4 v130, s[56:59], s64 offen lds
    s_add_u32 s64, s64, 128
    s_add_u32 m0, s36, 0x19000
    s_nop 0
    buffer_load_dwordx4 v130, s[56:59], s65 offen lds
    s_add_u32 s65, s65, 128
    s_add_u32 m0, s36, 0x1a000
    s_nop 0
    buffer_load_dwordx4 v130, s[56:59], s66 offen lds
    s_add_u32 s66, s66, 128
    s_add_u32 m0, s36, 0x1b000
    s_nop 0
    buffer_load_dwordx4 v130, s[56:59], s67 offen lds
    s_add_u32 s67, s67, 128
    s_add_u32 m0, s37, 0x1c000
    s_nop 0
    buffer_load_dwordx4 v128, s[60:63], s68 offen lds
    s_add_u32 s68, s68, s46
    s_add_u32 m0, s37, 0x1c400
    s_nop 0
    buffer_load_dwordx4 v128, s[60:63], s69 offen lds
    s_add_u32 s69, s69, s46
    ds_read_b128 v[132:135], v16 offset:0
    ds_read_b128 v[136:139], v16 offset:4096
    ds_read_b64_tr_b16 v[44:45], v14 offset:16384
    ds_read_b64_tr_b16 v[46:47], v14 offset:16896
    ds_read_b128 v[140:143], v17 offset:0
    ds_read_b128 v[144:147], v17 offset:4096
    ds_read_b64_tr_b16 v[48:49], v14 offset:17408
    ds_read_b64_tr_b16 v[50:51], v14 offset:17920
    s_waitcnt lgkmcnt(4)
    v_mfma_f32_32x32x16_bf16 v[96:111], v[44:47], v[132:135], v[96:111]
    v_mfma_f32_32x32x16_bf16 v[112:127], v[44:47], v[136:139], v[112:127]
    ds_read_b128 v[132:135], v18 offset:0
    ds_read_b128 v[136:139], v18 offset:4096
    ds_read_b64_tr_b16 v[44:45], v14 offset:18432
    ds_read_b64_tr_b16 v[46:47], v14 offset:18944
    s_waitcnt lgkmcnt(4)
    v_mfma_f32_32x32x16_bf16 v[96:111], v[48:51], v[140:143], v[96:111]
    v_mfma_f32_32x32x16_bf16 v[112:127], v[48:51], v[144:147], v[112:127]
    ds_read_b128 v[140:143], v19 offset:0
    ds_read_b128 v[144:147], v19 offset:4096
    ds_read_b64_tr_b16 v[48:49], v14 offset:19456
    ds_read_b64_tr_b16 v[50:51], v14 offset:19968
    s_waitcnt lgkmcnt(4)
    v_mfma_f32_32x32x16_bf16 v[96:111], v[44:47], v[132:135], v[96:111]
    v_mfma_f32_32x32x16_bf16 v[112:127], v[44:47], v[136:139], v[112:127]
    s_waitcnt lgkmcnt(0)
    v_mfma_f32_32x32x16_bf16 v[96:111], v[48:51], v[140:143], v[96:111]
    v_mfma_f32_32x32x16_bf16 v[112:127], v[48:51], v[144:147], v[112:127]
    s_waitcnt vmcnt(18)
    s_barrier
    s_add_u32 m0, s36, 0x0
    s_nop 0
    buffer_load_dwordx4 v130, s[56:59], s64 offen lds
    s_add_u32 s64, s64, 128
    s_add_u32 m0, s36, 0x1000
    s_nop 0
    buffer_load_dwordx4 v130, s[56:59], s65 offen lds
    s_add_u32 s65, s65, 128
    s_add_u32 m0, s36, 0x2000
    s_nop 0
    buffer_load_dwordx4 v130, s[56:59], s66 offen lds
    s_add_u32 s66, s66, 128
    s_add_u32 m0, s36, 0x3000
    s_nop 0
    buffer_load_dwordx4 v130, s[56:59], s67 offen lds
    s_add_u32 s67, s67, 128
    s_add_u32 m0, s37, 0x4000
    s_nop 0
    buffer_load_dwordx4 v128, s[60:63], s68 offen lds
    s_add_u32 s68, s68, s46
    s_add_u32 m0, s37, 0x4400
    s_nop 0
    buffer_load_dwordx4 v128, s[60:63], s69 offen lds
    s_add_u32 s69, s69, s46
    ds_read_b128 v[132:135], v22 offset:0
    ds_read_b128 v[136:139], v22 offset:4096
    ds_read_b64_tr_b16 v[44:45], v20 offset:16384
    ds_read_b64_tr_b16 v[46:47], v20 offset:16896
    ds_read_b128 v[140:143], v23 offset:0
    ds_read_b128 v[144:147], v23 offset:4096
    ds_read_b64_tr_b16 v[48:49], v20 offset:17408
    ds_read_b64_tr_b16 v[50:51], v20 offset:17920
    s_waitcnt lgkmcnt(4)
    v_mfma_f32_32x32x16_bf16 v[96:111], v[44:47], v[132:135], v[96:111]
    v_mfma_f32_32x32x16_bf16 v[112:127], v[44:47], v[136:139], v[112:127]
    ds_read_b128 v[132:135], v24 offset:0
    ds_read_b128 v[136:139], v24 offset:4096
    ds_read_b64_tr_b16 v[44:45], v20 offset:18432
    ds_read_b64_tr_b16 v[46:47], v20 offset:18944
    s_waitcnt lgkmcnt(4)
    v_mfma_f32_32x32x16_bf16 v[96:111], v[48:51], v[140:143], v[96:111]
    v_mfma_f32_32x32x16_bf16 v[112:127], v[48:51], v[144:147], v[112:127]
    ds_read_b128 v[140:143], v25 offset:0
    ds_read_b128 v[144:147], v25 offset:4096
    ds_read_b64_tr_b16 v[48:49], v20 offset:19456
    ds_read_b64_tr_b16 v[50:51], v20 offset:19968
    s_waitcnt lgkmcnt(4)
    v_mfma_f32_32x32x16_bf16 v[96:111], v[44:47], v[132:135], v[96:111]
    v_mfma_f32_32x32x16_bf16 v[112:127], v[44:47], v[136:139], v[112:127]
    s_waitcnt lgkmcnt(0)
    v_mfma_f32_32x32x16_bf16 v[96:111], v[48:51], v[140:143], v[96:111]
    v_mfma_f32_32x32x16_bf16 v[112:127], v[48:51], v[144:147], v[112:127]
    s_waitcnt vmcnt(18)
    s_barrier
    s_add_u32 m0, s36, 0x6000
    s_nop 0
    buffer_load_dwordx4 v130, s[56:59], s64 offen lds
    s_add_u32 s64, s64, 128
    s_add_u32 m0, s36, 0x7000
    s_nop 0
    buffer_load_dwordx4 v130, s[56:59], s65 offen lds
    s_add_u32 s65, s65, 128
    s_add_u32 m0, s36, 0x8000
    s_nop 0
    buffer_load_dwordx4 v130, s[56:59], s66 offen lds
    s_add_u32 s66, s66, 128
    s_add_u32 m0, s36, 0x9000
    s_nop 0
    buffer_load_dwordx4 v130, s[56:59], s67 offen lds
    s_add_u32 s67, s67, 128
    s_add_u32 m0, s37, 0xa000
    s_nop 0
    buffer_load_dwordx4 v128, s[60:63], s68 offen lds
    s_add_u32 s68, s68, s46
    s_add_u32 m0, s37, 0xa400
    s_nop 0
    buffer_load_dwordx4 v128, s[60:63], s69 offen lds
    s_add_u32 s69, s69, s46
    ds_read_b128 v[132:135], v28 offset:0
    ds_read_b128 v[136:139], v28 offset:4096
    ds_read_b64_tr_b16 v[44:45], v26 offset:16384
    ds_read_b64_tr_b16 v[46:47], v26 offset:16896
    ds_read_b128 v[140:143], v29 offset:0
    ds_read_b128 v[144:147], v29 offset:4096
    ds_read_b64_tr_b16 v[48:49], v26 offset:17408
    ds_read_b64_tr_b16 v[50:51], v26 offset:17920
    s_waitcnt lgkmcnt(4)
    v_mfma_f32_32x32x16_bf16 v[96:111], v[44:47], v[132:135], v[96:111]
    v_mfma_f32_32x32x16_bf16 v[112:127], v[44:47], v[136:139], v[112:127]
    ds_read_b128 v[132:135], v30 offset:0
    ds_read_b128 v[136:139], v30 offset:4096
    ds_read_b64_tr_b16 v[44:45], v26 offset:18432
    ds_read_b64_tr_b16 v[46:47], v26 offset:18944
    s_waitcnt lgkmcnt(4)
    v_mfma_f32_32x32x16_bf16 v[96:111], v[48:51], v[140:143], v[96:111]
    v_mfma_f32_32x32x16_bf16 v[112:127], v[48:51], v[144:147], v[112:127]
    ds_read_b128 v[140:143], v31 offset:0
    ds_read_b128 v[144:147], v31 offset:4096
    ds_read_b64_tr_b16 v[48:49], v26 offset:19456
    ds_read_b64_tr_b16 v[50:51], v26 offset:19968
    s_waitcnt lgkmcnt(4)
    v_mfma_f32_32x32x16_bf16 v[96:111], v[44:47], v[132:135], v[96:111]
    v_mfma_f32_32x32x16_bf16 v[112:127], v[44:47], v[136:139], v[112:127]
    s_waitcnt lgkmcnt(0)
    v_mfma_f32_32x32x16_bf16 v[96:111], v[48:51], v[140:143], v[96:111]
    v_mfma_f32_32x32x16_bf16 v[112:127], v[48:51], v[144:147], v[112:127]
    s_waitcnt vmcnt(18)
    s_barrier
    s_add_u32 m0, s36, 0xc000
    s_nop 0
    buffer_load_dwordx4 v130, s[56:59], s64 offen lds
    s_add_u32 s64, s64, 128
    s_add_u32 m0, s36, 0xd000
    s_nop 0
    buffer_load_dwordx4 v130, s[56:59], s65 offen lds
    s_add_u32 s65, s65, 128
    s_add_u32 m0, s36, 0xe000
    s_nop 0
    buffer_load_dwordx4 v130, s[56:59], s66 offen lds
    s_add_u32 s66, s66, 128
    s_add_u32 m0, s36, 0xf000
    s_nop 0
    buffer_load_dwordx4 v130, s[56:59], s67 offen lds
    s_add_u32 s67, s67, 128
    s_add_u32 m0, s37, 0x10000
    s_nop 0
    buffer_load_dwordx4 v128, s[60:63], s68 offen lds
    s_add_u32 s68, s68, s46
    s_add_u32 m0, s37, 0x10400
    s_nop 0
    buffer_load_dwordx4 v128, s[60:63], s69 offen lds
    s_add_u32 s69, s69, s46
    ds_read_b128 v[132:135], v34 offset:0
    ds_read_b128 v[136:139], v34 offset:4096
    ds_read_b64_tr_b16 v[44:45], v32 offset:16384
    ds_read_b64_tr_b16 v[46:47], v32 offset:16896
    ds_read_b128 v[140:143], v35 offset:0
    ds_read_b128 v[144:147], v35 offset:4096
    ds_read_b64_tr_b16 v[48:49], v32 offset:17408
    ds_read_b64_tr_b16 v[50:51], v32 offset:17920
    s_waitcnt lgkmcnt(4)
    v_mfma_f32_32x32x16_bf16 v[96:111], v[44:47], v[132:135], v[96:111]
    v_mfma_f32_32x32x16_bf16 v[112:127], v[44:47], v[136:139], v[112:127]
    ds_read_b128 v[132:135], v36 offset:0
    ds_read_b128 v[136:139], v36 offset:4096
    ds_read_b64_tr_b16 v[44:45], v32 offset:18432
    ds_read_b64_tr_b16 v[46:47], v32 offset:18944
    s_waitcnt lgkmcnt(4)
    v_mfma_f32_32x32x16_bf16 v[96:111], v[48:51], v[140:143], v[96:111]
    v_mfma_f32_32x32x16_bf16 v[112:127], v[48:51], v[144:147], v[112:127]
    ds_read_b128 v[140:143], v37 offset:0
    ds_read_b128 v[144:147], v37 offset:4096
    ds_read_b64_tr_b16 v[48:49], v32 offset:19456
    ds_read_b64_tr_b16 v[50:51], v32 offset:19968
    s_waitcnt lgkmcnt(4)
    v_mfma_f32_32x32x16_bf16 v[96:111], v[44:47], v[132:135], v[96:111]
    v_mfma_f32_32x32x16_bf16 v[112:127], v[44:47], v[136:139], v[112:127]
    s_waitcnt lgkmcnt(0)
    v_mfma_f32_32x32x16_bf16 v[96:111], v[48:51], v[140:143], v[96:111]
    v_mfma_f32_32x32x16_bf16 v[112:127], v[48:51], v[144:147], v[112:127]
    s_waitcnt vmcnt(18)
    s_barrier
    s_add_u32 m0, s36, 0x12000
    s_nop 0
    buffer_load_dwordx4 v130, s[56:59], s64 offen lds
    s_add_u32 s64, s64, 128
    s_add_u32 m0, s36, 0x13000
    s_nop 0
    buffer_load_dwordx4 v130, s[56:59], s65 offen lds
    s_add_u32 s65, s65, 128
    s_add_u32 m0, s36, 0x14000
    s_nop 0
    buffer_load_dwordx4 v130, s[56:59], s66 offen lds
    s_add_u32 s66, s66, 128
    s_add_u32 m0, s36, 0x15000
    s_nop 0
    buffer_load_dwordx4 v130, s[56:59], s67 offen lds
    s_add_u32 s67, s67, 128
    s_add_u32 m0, s37, 0x16000
    s_nop 0
    buffer_load_dwordx4 v128, s[60:63], s68 offen lds
    s_add_u32 s68, s68, s46
    s_add_u32 m0, s37, 0x16400
    s_nop 0
    buffer_load_dwordx4 v128, s[60:63], s69 offen lds
    s_add_u32 s69, s69, s46
    ds_read_b128 v[132:135], v40 offset:0
    ds_read_b128 v[136:139], v40 offset:4096
    ds_read_b64_tr_b16 v[44:45], v38 offset:16384
    ds_read_b64_tr_b16 v[46:47], v38 offset:16896
    ds_read_b128 v[140:143], v41 offset:0
    ds_read_b128 v[144:147], v41 offset:4096
    ds_read_b64_tr_b16 v[48:49], v38 offset:17408
    ds_read_b64_tr_b16 v[50:51], v38 offset:17920
    s_waitcnt lgkmcnt(4)
    v_mfma_f32_32x32x16_bf16 v[96:111], v[44:47], v[132:135], v[96:111]
    v_mfma_f32_32x32x16_bf16 v[112:127], v[44:47], v[136:139], v[112:127]
    ds_read_b128 v[132:135], v42 offset:0
    ds_read_b128 v[136:139], v42 offset:4096
    ds_read_b64_tr_b16 v[44:45], v38 offset:18432
    ds_read_b64_tr_b16 v[46:47], v38 offset:18944
    s_waitcnt lgkmcnt(4)
    v_mfma_f32_32x32x16_bf16 v[96:111], v[48:51], v[140:143], v[96:111]
    v_mfma_f32_32x32x16_bf16 v[112:127], v[48:51], v[144:147], v[112:127]
    ds_read_b128 v[140:143], v43 offset:0
    ds_read_b128 v[144:147], v43 offset:4096
    ds_read_b64_tr_b16 v[48:49], v38 offset:19456
    ds_read_b64_tr_b16 v[50:51], v38 offset:19968
    s_waitcnt lgkmcnt(4)
    v_mfma_f32_32x32x16_bf16 v[96:111], v[44:47], v[132:135], v[96:111]
    v_mfma_f32_32x32x16_bf16 v[112:127], v[44:47], v[136:139], v[112:127]
    s_waitcnt lgkmcnt(0)
    v_mfma_f32_32x32x16_bf16 v[96:111], v[48:51], v[140:143], v[96:111]
    v_mfma_f32_32x32x16_bf16 v[112:127], v[48:51], v[144:147], v[112:127]
    s_waitcnt vmcnt(18)
    s_barrier
    s_add_u32 m0, s36, 0x18000
    s_nop 0
    buffer_load_dwordx4 v130, s[56:59], s64 offen lds
    s_add_u32 s64, s64, 128
    s_add_u32 m0, s36, 0x19000
    s_nop 0
    buffer_load_dwordx4 v130, s[56:59], s65 offen lds
    s_add_u32 s65, s65, 128
    s_add_u32 m0, s36, 0x1a000
    s_nop 0
    buffer_load_dwordx4 v130, s[56:59], s66 offen lds
    s_add_u32 s66, s66, 128
    s_add_u32 m0, s36, 0x1b000
    s_nop 0
    buffer_load_dwordx4 v130, s[56:59], s67 offen lds
    s_add_u32 s67, s67, 128
    s_add_u32 m0, s37, 0x1c000
    s_nop 0
    buffer_load_dwordx4 v128, s[60:63], s68 offen lds
    s_add_u32 s68, s68, s46
    s_add_u32 m0, s37, 0x1c400
    s_nop 0
    buffer_load_dwordx4 v128, s[60:63], s69 offen lds
    s_add_u32 s69, s69, s46
    ds_read_b128 v[132:135], v16 offset:0
    ds_read_b128 v[136:139], v16 offset:4096
    ds_read_b64_tr_b16 v[44:45], v14 offset:16384
    ds_read_b64_tr_b16 v[46:47], v14 offset:16896
    ds_read_b128 v[140:143], v17 offset:0
    ds_read_b128 v[144:147], v17 offset:4096
    ds_read_b64_tr_b16 v[48:49], v14 offset:17408
    ds_read_b64_tr_b16 v[50:51], v14 offset:17920
    s_waitcnt lgkmcnt(4)
    v_mfma_f32_32x32x16_bf16 v[96:111], v[44:47], v[132:135], v[96:111]
    v_mfma_f32_32x32x16_bf16 v[112:127], v[44:47], v[136:139], v[112:127]
    ds_read_b128 v[132:135], v18 offset:0
    ds_read_b128 v[136:139], v18 offset:4096
    ds_read_b64_tr_b16 v[44:45], v14 offset:18432
    ds_read_b64_tr_b16 v[46:47], v14 offset:18944
    s_waitcnt lgkmcnt(4)
    v_mfma_f32_32x32x16_bf16 v[96:111], v[48:51], v[140:143], v[96:111]
    v_mfma_f32_32x32x16_bf16 v[112:127], v[48:51], v[144:147], v[112:127]
    ds_read_b128 v[140:143], v19 offset:0
    ds_read_b128 v[144:147], v19 offset:4096
    ds_read_b64_tr_b16 v[48:49], v14 offset:19456
    ds_read_b64_tr_b16 v[50:51], v14 offset:19968
    s_waitcnt lgkmcnt(4)
    v_mfma_f32_32x32x16_bf16 v[96:111], v[44:47], v[132:135], v[96:111]
    v_mfma_f32_32x32x16_bf16 v[112:127], v[44:47], v[136:139], v[112:127]
    s_waitcnt lgkmcnt(0)
    v_mfma_f32_32x32x16_bf16 v[96:111], v[48:51], v[140:143], v[96:111]
    v_mfma_f32_32x32x16_bf16 v[112:127], v[48:51], v[144:147], v[112:127]
    s_waitcnt vmcnt(18)
    s_barrier
    s_add_u32 m0, s36, 0x0
    s_nop 0
    buffer_load_dwordx4 v130, s[56:59], s64 offen lds
    s_add_u32 s64, s64, 128
    s_add_u32 m0, s36, 0x1000
    s_nop 0
    buffer_load_dwordx4 v130, s[56:59], s65 offen lds
    s_add_u32 s65, s65, 128
    s_add_u32 m0, s36, 0x2000
    s_nop 0
    buffer_load_dwordx4 v130, s[56:59], s66 offen lds
    s_add_u32 s66, s66, 128
    s_add_u32 m0, s36, 0x3000
    s_nop 0
    buffer_load_dwordx4 v130, s[56:59], s67 offen lds
    s_add_u32 s67, s67, 128
    s_add_u32 m0, s37, 0x4000
    s_nop 0
    buffer_load_dwordx4 v128, s[60:63], s68 offen lds
    s_add_u32 s68, s68, s46
    s_add_u32 m0, s37, 0x4400
    s_nop 0
    buffer_load_dwordx4 v128, s[60:63], s69 offen lds
    s_add_u32 s69, s69, s46
    ds_read_b128 v[132:135], v22 offset:0
    ds_read_b128 v[136:139], v22 offset:4096
    ds_read_b64_tr_b16 v[44:45], v20 offset:16384
    ds_read_b64_tr_b16 v[46:47], v20 offset:16896
    ds_read_b128 v[140:143], v23 offset:0
    ds_read_b128 v[144:147], v23 offset:4096
    ds_read_b64_tr_b16 v[48:49], v20 offset:17408
    ds_read_b64_tr_b16 v[50:51], v20 offset:17920
    s_waitcnt lgkmcnt(4)
    v_mfma_f32_32x32x16_bf16 v[96:111], v[44:47], v[132:135], v[96:111]
    v_mfma_f32_32x32x16_bf16 v[112:127], v[44:47], v[136:139], v[112:127]
    ds_read_b128 v[132:135], v24 offset:0
    ds_read_b128 v[136:139], v24 offset:4096
    ds_read_b64_tr_b16 v[44:45], v20 offset:18432
    ds_read_b64_tr_b16 v[46:47], v20 offset:18944
    s_waitcnt lgkmcnt(4)
    v_mfma_f32_32x32x16_bf16 v[96:111], v[48:51], v[140:143], v[96:111]
    v_mfma_f32_32x32x16_bf16 v[112:127], v[48:51], v[144:147], v[112:127]
    ds_read_b128 v[140:143], v25 offset:0
    ds_read_b128 v[144:147], v25 offset:4096
    ds_read_b64_tr_b16 v[48:49], v20 offset:19456
    ds_read_b64_tr_b16 v[50:51], v20 offset:19968
    s_waitcnt lgkmcnt(4)
    v_mfma_f32_32x32x16_bf16 v[96:111], v[44:47], v[132:135], v[96:111]
    v_mfma_f32_32x32x16_bf16 v[112:127], v[44:47], v[136:139], v[112:127]
    s_waitcnt lgkmcnt(0)
    v_mfma_f32_32x32x16_bf16 v[96:111], v[48:51], v[140:143], v[96:111]
    v_mfma_f32_32x32x16_bf16 v[112:127], v[48:51], v[144:147], v[112:127]
    s_waitcnt vmcnt(18)
    s_barrier
    s_add_u32 m0, s36, 0x6000
    s_nop 0
    buffer_load_dwordx4 v130, s[56:59], s64 offen lds
    s_add_u32 s64, s64, 128
    s_add_u32 m0, s36, 0x7000
    s_nop 0
    buffer_load_dwordx4 v130, s[56:59], s65 offen lds
    s_add_u32 s65, s65, 128
    s_add_u32 m0, s36, 0x8000
    s_nop 0
    buffer_load_dwordx4 v130, s[56:59], s66 offen lds
    s_add_u32 s66, s66, 128
    s_add_u32 m0, s36, 0x9000
    s_nop 0
    buffer_load_dwordx4 v130, s[56:59], s67 offen lds
    s_add_u32 s67, s67, 128
    s_add_u32 m0, s37, 0xa000
    s_nop 0
    buffer_load_dwordx4 v128, s[60:63], s68 offen lds
    s_add_u32 s68, s68, s46
    s_add_u32 m0, s37, 0xa400
    s_nop 0
    buffer_load_dwordx4 v128, s[60:63], s69 offen lds
    s_add_u32 s69, s69, s46
    ds_read_b128 v[132:135], v28 offset:0
    ds_read_b128 v[136:139], v28 offset:4096
    ds_read_b64_tr_b16 v[44:45], v26 offset:16384
    ds_read_b64_tr_b16 v[46:47], v26 offset:16896
    ds_read_b128 v[140:143], v29 offset:0
    ds_read_b128 v[144:147], v29 offset:4096
    ds_read_b64_tr_b16 v[48:49], v26 offset:17408
    ds_read_b64_tr_b16 v[50:51], v26 offset:17920
    s_waitcnt lgkmcnt(4)
    v_mfma_f32_32x32x16_bf16 v[96:111], v[44:47], v[132:135], v[96:111]
    v_mfma_f32_32x32x16_bf16 v[112:127], v[44:47], v[136:139], v[112:127]
    ds_read_b128 v[132:135], v30 offset:0
    ds_read_b128 v[136:139], v30 offset:4096
    ds_read_b64_tr_b16 v[44:45], v26 offset:18432
    ds_read_b64_tr_b16 v[46:47], v26 offset:18944
    s_waitcnt lgkmcnt(4)
    v_mfma_f32_32x32x16_bf16 v[96:111], v[48:51], v[140:143], v[96:111]
    v_mfma_f32_32x32x16_bf16 v[112:127], v[48:51], v[144:147], v[112:127]
    ds_read_b128 v[140:143], v31 offset:0
    ds_read_b128 v[144:147], v31 offset:4096
    ds_read_b64_tr_b16 v[48:49], v26 offset:19456
    ds_read_b64_tr_b16 v[50:51], v26 offset:19968
    s_waitcnt lgkmcnt(4)
    v_mfma_f32_32x32x16_bf16 v[96:111], v[44:47], v[132:135], v[96:111]
    v_mfma_f32_32x32x16_bf16 v[112:127], v[44:47], v[136:139], v[112:127]
    s_waitcnt lgkmcnt(0)
    v_mfma_f32_32x32x16_bf16 v[96:111], v[48:51], v[140:143], v[96:111]
    v_mfma_f32_32x32x16_bf16 v[112:127], v[48:51], v[144:147], v[112:127]
    s_waitcnt vmcnt(18)
    s_barrier
    s_add_u32 m0, s36, 0xc000
    s_nop 0
    buffer_load_dwordx4 v130, s[56:59], s64 offen lds
    s_add_u32 s64, s64, 128
    s_add_u32 m0, s36, 0xd000
    s_nop 0
    buffer_load_dwordx4 v130, s[56:59], s65 offen lds
    s_add_u32 s65, s65, 128
    s_add_u32 m0, s36, 0xe000
    s_nop 0
    buffer_load_dwordx4 v130, s[56:59], s66 offen lds
    s_add_u32 s66, s66, 128
    s_add_u32 m0, s36, 0xf000
    s_nop 0
    buffer_load_dwordx4 v130, s[56:59], s67 offen lds
    s_add_u32 s67, s67, 128
    s_add_u32 m0, s37, 0x10000
    s_nop 0
    buffer_load_dwordx4 v128, s[60:63], s68 offen lds
    s_add_u32 s68, s68, s46
    s_add_u32 m0, s37, 0x10400
    s_nop 0
    buffer_load_dwordx4 v128, s[60:63], s69 offen lds
    s_add_u32 s69, s69, s46
    ds_read_b128 v[132:135], v34 offset:0
    ds_read_b128 v[136:139], v34 offset:4096
    ds_read_b64_tr_b16 v[44:45], v32 offset:16384
    ds_read_b64_tr_b16 v[46:47], v32 offset:16896
    ds_read_b128 v[140:143], v35 offset:0
    ds_read_b128 v[144:147], v35 offset:4096
    ds_read_b64_tr_b16 v[48:49], v32 offset:17408
    ds_read_b64_tr_b16 v[50:51], v32 offset:17920
    s_waitcnt lgkmcnt(4)
    v_mfma_f32_32x32x16_bf16 v[96:111], v[44:47], v[132:135], v[96:111]
    v_mfma_f32_32x32x16_bf16 v[112:127], v[44:47], v[136:139], v[112:127]
    ds_read_b128 v[132:135], v36 offset:0
    ds_read_b128 v[136:139], v36 offset:4096
    ds_read_b64_tr_b16 v[44:45], v32 offset:18432
    ds_read_b64_tr_b16 v[46:47], v32 offset:18944
    s_waitcnt lgkmcnt(4)
    v_mfma_f32_32x32x16_bf16 v[96:111], v[48:51], v[140:143], v[96:111]
    v_mfma_f32_32x32x16_bf16 v[112:127], v[48:51], v[144:147], v[112:127]
    ds_read_b128 v[140:143], v37 offset:0
    ds_read_b128 v[144:147], v37 offset:4096
    ds_read_b64_tr_b16 v[48:49], v32 offset:19456
    ds_read_b64_tr_b16 v[50:51], v32 offset:19968
    s_waitcnt lgkmcnt(4)
    v_mfma_f32_32x32x16_bf16 v[96:111], v[44:47], v[132:135], v[96:111]
    v_mfma_f32_32x32x16_bf16 v[112:127], v[44:47], v[136:139], v[112:127]
    s_waitcnt lgkmcnt(0)
    v_mfma_f32_32x32x16_bf16 v[96:111], v[48:51], v[140:143], v[96:111]
    v_mfma_f32_32x32x16_bf16 v[112:127], v[48:51], v[144:147], v[112:127]
    s_waitcnt vmcnt(18)
    s_barrier
    s_add_u32 m0, s36, 0x12000
    s_nop 0
    buffer_load_dwordx4 v130, s[56:59], s64 offen lds
    s_add_u32 s64, s64, 128
    s_add_u32 m0, s36, 0x13000
    s_nop 0
    buffer_load_dwordx4 v130, s[56:59], s65 offen lds
    s_add_u32 s65, s65, 128
    s_add_u32 m0, s36, 0x14000
    s_nop 0
    buffer_load_dwordx4 v130, s[56:59], s66 offen lds
    s_add_u32 s66, s66, 128
    s_add_u32 m0, s36, 0x15000
    s_nop 0
    buffer_load_dwordx4 v130, s[56:59], s67 offen lds
    s_add_u32 s67, s67, 128
    s_add_u32 m0, s37, 0x16000
    s_nop 0
    buffer_load_dwordx4 v128, s[60:63], s68 offen lds
    s_add_u32 s68, s68, s46
    s_add_u32 m0, s37, 0x16400
    s_nop 0
    buffer_load_dwordx4 v128, s[60:63], s69 offen lds
    s_add_u32 s69, s69, s46
    ds_read_b128 v[132:135], v40 offset:0
    ds_read_b128 v[136:139], v40 offset:4096
    ds_read_b64_tr_b16 v[44:45], v38 offset:16384
    ds_read_b64_tr_b16 v[46:47], v38 offset:16896
    ds_read_b128 v[140:143], v41 offset:0
    ds_read_b128 v[144:147], v41 offset:4096
    ds_read_b64_tr_b16 v[48:49], v38 offset:17408
    ds_read_b64_tr_b16 v[50:51], v38 offset:17920
    s_waitcnt lgkmcnt(4)
    v_mfma_f32_32x32x16_bf16 v[96:111], v[44:47], v[132:135], v[96:111]
    v_mfma_f32_32x32x16_bf16 v[112:127], v[44:47], v[136:139], v[112:127]
    ds_read_b128 v[132:135], v42 offset:0
    ds_read_b128 v[136:139], v42 offset:4096
    ds_read_b64_tr_b16 v[44:45], v38 offset:18432
    ds_read_b64_tr_b16 v[46:47], v38 offset:18944
    s_waitcnt lgkmcnt(4)
    v_mfma_f32_32x32x16_bf16 v[96:111], v[48:51], v[140:143], v[96:111]
    v_mfma_f32_32x32x16_bf16 v[112:127], v[48:51], v[144:147], v[112:127]
    ds_read_b128 v[140:143], v43 offset:0
    ds_read_b128 v[144:147], v43 offset:4096
    ds_read_b64_tr_b16 v[48:49], v38 offset:19456
    ds_read_b64_tr_b16 v[50:51], v38 offset:19968
    s_waitcnt lgkmcnt(4)
    v_mfma_f32_32x32x16_bf16 v[96:111], v[44:47], v[132:135], v[96:111]
    v_mfma_f32_32x32x16_bf16 v[112:127], v[44:47], v[136:139], v[112:127]
    s_waitcnt lgkmcnt(0)
    v_mfma_f32_32x32x16_bf16 v[96:111], v[48:51], v[140:143], v[96:111]
    v_mfma_f32_32x32x16_bf16 v[112:127], v[48:51], v[144:147], v[112:127]
    s_waitcnt vmcnt(18)
    s_barrier
    s_add_u32 m0, s36, 0x18000
    s_nop 0
    buffer_load_dwordx4 v130, s[56:59], s64 offen lds
    s_add_u32 s64, s64, 128
    s_add_u32 m0, s36, 0x19000
    s_nop 0
    buffer_load_dwordx4 v130, s[56:59], s65 offen lds
    s_add_u32 s65, s65, 128
    s_add_u32 m0, s36, 0x1a000
    s_nop 0
    buffer_load_dwordx4 v130, s[56:59], s66 offen lds
    s_add_u32 s66, s66, 128
    s_add_u32 m0, s36, 0x1b000
    s_nop 0
    buffer_load_dwordx4 v130, s[56:59], s67 offen lds
    s_add_u32 s67, s67, 128
    s_add_u32 m0, s37, 0x1c000
    s_nop 0
    buffer_load_dwordx4 v128, s[60:63], s68 offen lds
    s_add_u32 s68, s68, s46
    s_add_u32 m0, s37, 0x1c400
    s_nop 0
    buffer_load_dwordx4 v128, s[60:63], s69 offen lds
    s_add_u32 s69, s69, s46
    ds_read_b128 v[132:135], v16 offset:0
    ds_read_b128 v[136:139], v16 offset:4096
    ds_read_b64_tr_b16 v[44:45], v14 offset:16384
    ds_read_b64_tr_b16 v[46:47], v14 offset:16896
    ds_read_b128 v[140:143], v17 offset:0
    ds_read_b128 v[144:147], v17 offset:4096
    ds_read_b64_tr_b16 v[48:49], v14 offset:17408
    ds_read_b64_tr_b16 v[50:51], v14 offset:17920
    s_waitcnt lgkmcnt(4)
    v_mfma_f32_32x32x16_bf16 v[96:111], v[44:47], v[132:135], v[96:111]
    v_mfma_f32_32x32x16_bf16 v[112:127], v[44:47], v[136:139], v[112:127]
    ds_read_b128 v[132:135], v18 offset:0
    ds_read_b128 v[136:139], v18 offset:4096
    ds_read_b64_tr_b16 v[44:45], v14 offset:18432
    ds_read_b64_tr_b16 v[46:47], v14 offset:18944
    s_waitcnt lgkmcnt(4)
    v_mfma_f32_32x32x16_bf16 v[96:111], v[48:51], v[140:143], v[96:111]
    v_mfma_f32_32x32x16_bf16 v[112:127], v[48:51], v[144:147], v[112:127]
    ds_read_b128 v[140:143], v19 offset:0
    ds_read_b128 v[144:147], v19 offset:4096
    ds_read_b64_tr_b16 v[48:49], v14 offset:19456
    ds_read_b64_tr_b16 v[50:51], v14 offset:19968
    s_waitcnt lgkmcnt(4)
    v_mfma_f32_32x32x16_bf16 v[96:111], v[44:47], v[132:135], v[96:111]
    v_mfma_f32_32x32x16_bf16 v[112:127], v[44:47], v[136:139], v[112:127]
    s_waitcnt lgkmcnt(0)
    v_mfma_f32_32x32x16_bf16 v[96:111], v[48:51], v[140:143], v[96:111]
    v_mfma_f32_32x32x16_bf16 v[112:127], v[48:51], v[144:147], v[112:127]
    s_waitcnt vmcnt(18)
    s_barrier
    s_add_u32 m0, s36, 0x0
    s_nop 0
    buffer_load_dwordx4 v130, s[56:59], s64 offen lds
    s_add_u32 s64, s64, 128
    s_add_u32 m0, s36, 0x1000
    s_nop 0
    buffer_load_dwordx4 v130, s[56:59], s65 offen lds
    s_add_u32 s65, s65, 128
    s_add_u32 m0, s36, 0x2000
    s_nop 0
    buffer_load_dwordx4 v130, s[56:59], s66 offen lds
    s_add_u32 s66, s66, 128
    s_add_u32 m0, s36, 0x3000
    s_nop 0
    buffer_load_dwordx4 v130, s[56:59], s67 offen lds
    s_add_u32 s67, s67, 128
    s_add_u32 m0, s37, 0x4000
    s_nop 0
    buffer_load_dwordx4 v128, s[60:63], s68 offen lds
    s_add_u32 s68, s68, s46
    s_add_u32 m0, s37, 0x4400
    s_nop 0
    buffer_load_dwordx4 v128, s[60:63], s69 offen lds
    s_add_u32 s69, s69, s46
    ds_read_b128 v[132:135], v22 offset:0
    ds_read_b128 v[136:139], v22 offset:4096
    ds_read_b64_tr_b16 v[44:45], v20 offset:16384
    ds_read_b64_tr_b16 v[46:47], v20 offset:16896
    ds_read_b128 v[140:143], v23 offset:0
    ds_read_b128 v[144:147], v23 offset:4096
    ds_read_b64_tr_b16 v[48:49], v20 offset:17408
    ds_read_b64_tr_b16 v[50:51], v20 offset:17920
    s_waitcnt lgkmcnt(4)
    v_mfma_f32_32x32x16_bf16 v[96:111], v[44:47], v[132:135], v[96:111]
    v_mfma_f32_32x32x16_bf16 v[112:127], v[44:47], v[136:139], v[112:127]
    ds_read_b128 v[132:135], v24 offset:0
    ds_read_b128 v[136:139], v24 offset:4096
    ds_read_b64_tr_b16 v[44:45], v20 offset:18432
    ds_read_b64_tr_b16 v[46:47], v20 offset:18944
    s_waitcnt lgkmcnt(4)
    v_mfma_f32_32x32x16_bf16 v[96:111], v[48:51], v[140:143], v[96:111]
    v_mfma_f32_32x32x16_bf16 v[112:127], v[48:51], v[144:147], v[112:127]
    ds_read_b128 v[140:143], v25 offset:0
    ds_read_b128 v[144:147], v25 offset:4096
    ds_read_b64_tr_b16 v[48:49], v20 offset:19456
    ds_read_b64_tr_b16 v[50:51], v20 offset:19968
    s_waitcnt lgkmcnt(4)
    v_mfma_f32_32x32x16_bf16 v[96:111], v[44:47], v[132:135], v[96:111]
    v_mfma_f32_32x32x16_bf16 v[112:127], v[44:47], v[136:139], v[112:127]
    s_waitcnt lgkmcnt(0)
    v_mfma_f32_32x32x16_bf16 v[96:111], v[48:51], v[140:143], v[96:111]
    v_mfma_f32_32x32x16_bf16 v[112:127], v[48:51], v[144:147], v[112:127]
    s_waitcnt vmcnt(18)
    s_barrier
    s_add_u32 m0, s36, 0x6000
    s_nop 0
    buffer_load_dwordx4 v130, s[56:59], s64 offen lds
    s_add_u32 s64, s64, 128
    s_add_u32 m0, s36, 0x7000
    s_nop 0
    buffer_load_dwordx4 v130, s[56:59], s65 offen lds
    s_add_u32 s65, s65, 128
    s_add_u32 m0, s36, 0x8000
    s_nop 0
    buffer_load_dwordx4 v130, s[56:59], s66 offen lds
    s_add_u32 s66, s66, 128
    s_add_u32 m0, s36, 0x9000
    s_nop 0
    buffer_load_dwordx4 v130, s[56:59], s67 offen lds
    s_add_u32 s67, s67, 128
    s_add_u32 m0, s37, 0xa000
    s_nop 0
    buffer_load_dwordx4 v128, s[60:63], s68 offen lds
    s_add_u32 s68, s68, s46
    s_add_u32 m0, s37, 0xa400
    s_nop 0
    buffer_load_dwordx4 v128, s[60:63], s69 offen lds
    s_add_u32 s69, s69, s46
    ds_read_b128 v[132:135], v28 offset:0
    ds_read_b128 v[136:139], v28 offset:4096
    ds_read_b64_tr_b16 v[44:45], v26 offset:16384
    ds_read_b64_tr_b16 v[46:47], v26 offset:16896
    ds_read_b128 v[140:143], v29 offset:0
    ds_read_b128 v[144:147], v29 offset:4096
    ds_read_b64_tr_b16 v[48:49], v26 offset:17408
    ds_read_b64_tr_b16 v[50:51], v26 offset:17920
    s_waitcnt lgkmcnt(4)
    v_mfma_f32_32x32x16_bf16 v[96:111], v[44:47], v[132:135], v[96:111]
    v_mfma_f32_32x32x16_bf16 v[112:127], v[44:47], v[136:139], v[112:127]
    ds_read_b128 v[132:135], v30 offset:0
    ds_read_b128 v[136:139], v30 offset:4096
    ds_read_b64_tr_b16 v[44:45], v26 offset:18432
    ds_read_b64_tr_b16 v[46:47], v26 offset:18944
    s_waitcnt lgkmcnt(4)
    v_mfma_f32_32x32x16_bf16 v[96:111], v[48:51], v[140:143], v[96:111]
    v_mfma_f32_32x32x16_bf16 v[112:127], v[48:51], v[144:147], v[112:127]
    ds_read_b128 v[140:143], v31 offset:0
    ds_read_b128 v[144:147], v31 offset:4096
    ds_read_b64_tr_b16 v[48:49], v26 offset:19456
    ds_read_b64_tr_b16 v[50:51], v26 offset:19968
    s_waitcnt lgkmcnt(4)
    v_mfma_f32_32x32x16_bf16 v[96:111], v[44:47], v[132:135], v[96:111]
    v_mfma_f32_32x32x16_bf16 v[112:127], v[44:47], v[136:139], v[112:127]
    s_waitcnt lgkmcnt(0)
    v_mfma_f32_32x32x16_bf16 v[96:111], v[48:51], v[140:143], v[96:111]
    v_mfma_f32_32x32x16_bf16 v[112:127], v[48:51], v[144:147], v[112:127]
    s_waitcnt vmcnt(18)
    s_barrier
    s_add_u32 m0, s36, 0xc000
    s_nop 0
    buffer_load_dwordx4 v130, s[56:59], s64 offen lds
    s_add_u32 s64, s64, 128
    s_add_u32 m0, s36, 0xd000
    s_nop 0
    buffer_load_dwordx4 v130, s[56:59], s65 offen lds
    s_add_u32 s65, s65, 128
    s_add_u32 m0, s36, 0xe000
    s_nop 0
    buffer_load_dwordx4 v130, s[56:59], s66 offen lds
    s_add_u32 s66, s66, 128
    s_add_u32 m0, s36, 0xf000
    s_nop 0
    buffer_load_dwordx4 v130, s[56:59], s67 offen lds
    s_add_u32 s67, s67, 128
    s_add_u32 m0, s37, 0x10000
    s_nop 0
    buffer_load_dwordx4 v128, s[60:63], s68 offen lds
    s_add_u32 s68, s68, s46
    s_add_u32 m0, s37, 0x10400
    s_nop 0
    buffer_load_dwordx4 v128, s[60:63], s69 offen lds
    s_add_u32 s69, s69, s46
    ds_read_b128 v[132:135], v34 offset:0
    ds_read_b128 v[136:139], v34 offset:4096
    ds_read_b64_tr_b16 v[44:45], v32 offset:16384
    ds_read_b64_tr_b16 v[46:47], v32 offset:16896
    ds_read_b128 v[140:143], v35 offset:0
    ds_read_b128 v[144:147], v35 offset:4096
    ds_read_b64_tr_b16 v[48:49], v32 offset:17408
    ds_read_b64_tr_b16 v[50:51], v32 offset:17920
    s_waitcnt lgkmcnt(4)
    v_mfma_f32_32x32x16_bf16 v[96:111], v[44:47], v[132:135], v[96:111]
    v_mfma_f32_32x32x16_bf16 v[112:127], v[44:47], v[136:139], v[112:127]
    ds_read_b128 v[132:135], v36 offset:0
    ds_read_b128 v[136:139], v36 offset:4096
    ds_read_b64_tr_b16 v[44:45], v32 offset:18432
    ds_read_b64_tr_b16 v[46:47], v32 offset:18944
    s_waitcnt lgkmcnt(4)
    v_mfma_f32_32x32x16_bf16 v[96:111], v[48:51], v[140:143], v[96:111]
    v_mfma_f32_32x32x16_bf16 v[112:127], v[48:51], v[144:147], v[112:127]
    ds_read_b128 v[140:143], v37 offset:0
    ds_read_b128 v[144:147], v37 offset:4096
    ds_read_b64_tr_b16 v[48:49], v32 offset:19456
    ds_read_b64_tr_b16 v[50:51], v32 offset:19968
    s_waitcnt lgkmcnt(4)
    v_mfma_f32_32x32x16_bf16 v[96:111], v[44:47], v[132:135], v[96:111]
    v_mfma_f32_32x32x16_bf16 v[112:127], v[44:47], v[136:139], v[112:127]
    s_waitcnt lgkmcnt(0)
    v_mfma_f32_32x32x16_bf16 v[96:111], v[48:51], v[140:143], v[96:111]
    v_mfma_f32_32x32x16_bf16 v[112:127], v[48:51], v[144:147], v[112:127]
    s_waitcnt vmcnt(18)
    s_barrier
    s_add_u32 m0, s36, 0x12000
    s_nop 0
    buffer_load_dwordx4 v130, s[56:59], s64 offen lds
    s_add_u32 s64, s64, 128
    s_add_u32 m0, s36, 0x13000
    s_nop 0
    buffer_load_dwordx4 v130, s[56:59], s65 offen lds
    s_add_u32 s65, s65, 128
    s_add_u32 m0, s36, 0x14000
    s_nop 0
    buffer_load_dwordx4 v130, s[56:59], s66 offen lds
    s_add_u32 s66, s66, 128
    s_add_u32 m0, s36, 0x15000
    s_nop 0
    buffer_load_dwordx4 v130, s[56:59], s67 offen lds
    s_add_u32 s67, s67, 128
    s_add_u32 m0, s37, 0x16000
    s_nop 0
    buffer_load_dwordx4 v128, s[60:63], s68 offen lds
    s_add_u32 s68, s68, s46
    s_add_u32 m0, s37, 0x16400
    s_nop 0
    buffer_load_dwordx4 v128, s[60:63], s69 offen lds
    s_add_u32 s69, s69, s46
    ds_read_b128 v[132:135], v40 offset:0
    ds_read_b128 v[136:139], v40 offset:4096
    ds_read_b64_tr_b16 v[44:45], v38 offset:16384
    ds_read_b64_tr_b16 v[46:47], v38 offset:16896
    ds_read_b128 v[140:143], v41 offset:0
    ds_read_b128 v[144:147], v41 offset:4096
    ds_read_b64_tr_b16 v[48:49], v38 offset:17408
    ds_read_b64_tr_b16 v[50:51], v38 offset:17920
    s_waitcnt lgkmcnt(4)
    v_mfma_f32_32x32x16_bf16 v[96:111], v[44:47], v[132:135], v[96:111]
    v_mfma_f32_32x32x16_bf16 v[112:127], v[44:47], v[136:139], v[112:127]
    ds_read_b128 v[132:135], v42 offset:0
    ds_read_b128 v[136:139], v42 offset:4096
    ds_read_b64_tr_b16 v[44:45], v38 offset:18432
    ds_read_b64_tr_b16 v[46:47], v38 offset:18944
    s_waitcnt lgkmcnt(4)
    v_mfma_f32_32x32x16_bf16 v[96:111], v[48:51], v[140:143], v[96:111]
    v_mfma_f32_32x32x16_bf16 v[112:127], v[48:51], v[144:147], v[112:127]
    ds_read_b128 v[140:143], v43 offset:0
    ds_read_b128 v[144:147], v43 offset:4096
    ds_read_b64_tr_b16 v[48:49], v38 offset:19456
    ds_read_b64_tr_b16 v[50:51], v38 offset:19968
    s_waitcnt lgkmcnt(4)
    v_mfma_f32_32x32x16_bf16 v[96:111], v[44:47], v[132:135], v[96:111]
    v_mfma_f32_32x32x16_bf16 v[112:127], v[44:47], v[136:139], v[112:127]
    s_waitcnt lgkmcnt(0)
    v_mfma_f32_32x32x16_bf16 v[96:111], v[48:51], v[140:143], v[96:111]
    v_mfma_f32_32x32x16_bf16 v[112:127], v[48:51], v[144:147], v[112:127]
    s_waitcnt vmcnt(18)
    s_barrier
    ds_read_b128 v[132:135], v16 offset:0
    ds_read_b128 v[136:139], v16 offset:4096
    ds_read_b64_tr_b16 v[44:45], v14 offset:16384
    ds_read_b64_tr_b16 v[46:47], v14 offset:16896
    ds_read_b128 v[140:143], v17 offset:0
    ds_read_b128 v[144:147], v17 offset:4096
    ds_read_b64_tr_b16 v[48:49], v14 offset:17408
    ds_read_b64_tr_b16 v[50:51], v14 offset:17920
    s_waitcnt lgkmcnt(4)
    v_mfma_f32_32x32x16_bf16 v[96:111], v[44:47], v[132:135], v[96:111]
    v_mfma_f32_32x32x16_bf16 v[112:127], v[44:47], v[136:139], v[112:127]
    ds_read_b128 v[132:135], v18 offset:0
    ds_read_b128 v[136:139], v18 offset:4096
    ds_read_b64_tr_b16 v[44:45], v14 offset:18432
    ds_read_b64_tr_b16 v[46:47], v14 offset:18944
    s_waitcnt lgkmcnt(4)
    v_mfma_f32_32x32x16_bf16 v[96:111], v[48:51], v[140:143], v[96:111]
    v_mfma_f32_32x32x16_bf16 v[112:127], v[48:51], v[144:147], v[112:127]
    ds_read_b128 v[140:143], v19 offset:0
    ds_read_b128 v[144:147], v19 offset:4096
    ds_read_b64_tr_b16 v[48:49], v14 offset:19456
    ds_read_b64_tr_b16 v[50:51], v14 offset:19968
    s_waitcnt lgkmcnt(4)
    v_mfma_f32_32x32x16_bf16 v[96:111], v[44:47], v[132:135], v[96:111]
    v_mfma_f32_32x32x16_bf16 v[112:127], v[44:47], v[136:139], v[112:127]
    s_waitcnt lgkmcnt(0)
    v_mfma_f32_32x32x16_bf16 v[96:111], v[48:51], v[140:143], v[96:111]
    v_mfma_f32_32x32x16_bf16 v[112:127], v[48:51], v[144:147], v[112:127]
    s_waitcnt vmcnt(12)
    s_barrier
    ds_read_b128 v[132:135], v22 offset:0
    ds_read_b128 v[136:139], v22 offset:4096
    ds_read_b64_tr_b16 v[44:45], v20 offset:16384
    ds_read_b64_tr_b16 v[46:47], v20 offset:16896
    ds_read_b128 v[140:143], v23 offset:0
    ds_read_b128 v[144:147], v23 offset:4096
    ds_read_b64_tr_b16 v[48:49], v20 offset:17408
    ds_read_b64_tr_b16 v[50:51], v20 offset:17920
    s_waitcnt lgkmcnt(4)
    v_mfma_f32_32x32x16_bf16 v[96:111], v[44:47], v[132:135], v[96:111]
    v_mfma_f32_32x32x16_bf16 v[112:127], v[44:47], v[136:139], v[112:127]
    ds_read_b128 v[132:135], v24 offset:0
    ds_read_b128 v[136:139], v24 offset:4096
    ds_read_b64_tr_b16 v[44:45], v20 offset:18432
    ds_read_b64_tr_b16 v[46:47], v20 offset:18944
    s_waitcnt lgkmcnt(4)
    v_mfma_f32_32x32x16_bf16 v[96:111], v[48:51], v[140:143], v[96:111]
    v_mfma_f32_32x32x16_bf16 v[112:127], v[48:51], v[144:147], v[112:127]
    ds_read_b128 v[140:143], v25 offset:0
    ds_read_b128 v[144:147], v25 offset:4096
    ds_read_b64_tr_b16 v[48:49], v20 offset:19456
    ds_read_b64_tr_b16 v[50:51], v20 offset:19968
    s_waitcnt lgkmcnt(4)
    v_mfma_f32_32x32x16_bf16 v[96:111], v[44:47], v[132:135], v[96:111]
    v_mfma_f32_32x32x16_bf16 v[112:127], v[44:47], v[136:139], v[112:127]
    s_waitcnt lgkmcnt(0)
    v_mfma_f32_32x32x16_bf16 v[96:111], v[48:51], v[140:143], v[96:111]
    v_mfma_f32_32x32x16_bf16 v[112:127], v[48:51], v[144:147], v[112:127]
    s_waitcnt vmcnt(6)
    s_barrier
    ds_read_b128 v[132:135], v28 offset:0
    ds_read_b128 v[136:139], v28 offset:4096
    ds_read_b64_tr_b16 v[44:45], v26 offset:16384
    ds_read_b64_tr_b16 v[46:47], v26 offset:16896
    ds_read_b128 v[140:143], v29 offset:0
    ds_read_b128 v[144:147], v29 offset:4096
    ds_read_b64_tr_b16 v[48:49], v26 offset:17408
    ds_read_b64_tr_b16 v[50:51], v26 offset:17920
    s_waitcnt lgkmcnt(4)
    v_mfma_f32_32x32x16_bf16 v[96:111], v[44:47], v[132:135], v[96:111]
    v_mfma_f32_32x32x16_bf16 v[112:127], v[44:47], v[136:139], v[112:127]
    ds_read_b128 v[132:135], v30 offset:0
    ds_read_b128 v[136:139], v30 offset:4096
    ds_read_b64_tr_b16 v[44:45], v26 offset:18432
    ds_read_b64_tr_b16 v[46:47], v26 offset:18944
    s_waitcnt lgkmcnt(4)
    v_mfma_f32_32x32x16_bf16 v[96:111], v[48:51], v[140:143], v[96:111]
    v_mfma_f32_32x32x16_bf16 v[112:127], v[48:51], v[144:147], v[112:127]
    ds_read_b128 v[140:143], v31 offset:0
    ds_read_b128 v[144:147], v31 offset:4096
    ds_read_b64_tr_b16 v[48:49], v26 offset:19456
    ds_read_b64_tr_b16 v[50:51], v26 offset:19968
    s_waitcnt lgkmcnt(4)
    v_mfma_f32_32x32x16_bf16 v[96:111], v[44:47], v[132:135], v[96:111]
    v_mfma_f32_32x32x16_bf16 v[112:127], v[44:47], v[136:139], v[112:127]
    s_waitcnt lgkmcnt(0)
    v_mfma_f32_32x32x16_bf16 v[96:111], v[48:51], v[140:143], v[96:111]
    v_mfma_f32_32x32x16_bf16 v[112:127], v[48:51], v[144:147], v[112:127]
    s_waitcnt vmcnt(0)
    s_barrier
    ds_read_b128 v[132:135], v34 offset:0
    ds_read_b128 v[136:139], v34 offset:4096
    ds_read_b64_tr_b16 v[44:45], v32 offset:16384
    ds_read_b64_tr_b16 v[46:47], v32 offset:16896
    ds_read_b128 v[140:143], v35 offset:0
    ds_read_b128 v[144:147], v35 offset:4096
    ds_read_b64_tr_b16 v[48:49], v32 offset:17408
    ds_read_b64_tr_b16 v[50:51], v32 offset:17920
    s_waitcnt lgkmcnt(4)
    v_mfma_f32_32x32x16_bf16 v[96:111], v[44:47], v[132:135], v[96:111]
    v_mfma_f32_32x32x16_bf16 v[112:127], v[44:47], v[136:139], v[112:127]
    ds_read_b128 v[132:135], v36 offset:0
    ds_read_b128 v[136:139], v36 offset:4096
    ds_read_b64_tr_b16 v[44:45], v32 offset:18432
    ds_read_b64_tr_b16 v[46:47], v32 offset:18944
    s_waitcnt lgkmcnt(4)
    v_mfma_f32_32x32x16_bf16 v[96:111], v[48:51], v[140:143], v[96:111]
    v_mfma_f32_32x32x16_bf16 v[112:127], v[48:51], v[144:147], v[112:127]
    ds_read_b128 v[140:143], v37 offset:0
    ds_read_b128 v[144:147], v37 offset:4096
    ds_read_b64_tr_b16 v[48:49], v32 offset:19456
    ds_read_b64_tr_b16 v[50:51], v32 offset:19968
    s_waitcnt lgkmcnt(4)
    v_mfma_f32_32x32x16_bf16 v[96:111], v[44:47], v[132:135], v[96:111]
    v_mfma_f32_32x32x16_bf16 v[112:127], v[44:47], v[136:139], v[112:127]
    s_waitcnt lgkmcnt(0)
    v_mfma_f32_32x32x16_bf16 v[96:111], v[48:51], v[140:143], v[96:111]
    v_mfma_f32_32x32x16_bf16 v[112:127], v[48:51], v[144:147], v[112:127]
    s_nop 15
    s_mov_b32 s20, s10
    s_and_b32 s21, s11, 0xffff
    s_mov_b32 s22, 0x280000
    s_mov_b32 s23, 0x20000
    s_mov_b32 s40, s50
    s_and_b32 s41, s51, 0xffff
    s_mov_b32 s42, 0x280000
    s_mov_b32 s43, 0x20000
    v_and_b32 v21, 15, v0
    v_lshrrev_b32 v22, 4, v0
    s_lshl_b32 s52, s24, 7
    v_add_u32 v23, s52, v22
    v_mul_u32_u24 v23, 1280, v23
    v_lshl_add_u32 v23, v21, 3, v23
    s_lshl_b32 s52, s25, 7
    v_add_u32 v23, s52, v23
    s_mov_b32 s53, 0
    buffer_load_dwordx2 v[32:33], v23, s[20:23], s53 offen
    s_add_u32 s53, s53, 20480
    buffer_load_dwordx2 v[34:35], v23, s[20:23], s53 offen
    s_add_u32 s53, s53, 20480
    buffer_load_dwordx2 v[36:37], v23, s[20:23], s53 offen
    s_add_u32 s53, s53, 20480
    buffer_load_dwordx2 v[38:39], v23, s[20:23], s53 offen
    s_add_u32 s53, s53, 20480
    buffer_load_dwordx2 v[40:41], v23, s[20:23], s53 offen
    s_add_u32 s53, s53, 20480
    buffer_load_dwordx2 v[42:43], v23, s[20:23], s53 offen
    s_add_u32 s53, s53, 20480
    buffer_load_dwordx2 v[44:45], v23, s[20:23], s53 offen
    s_add_u32 s53, s53, 20480
    buffer_load_dwordx2 v[46:47], v23, s[20:23], s53 offen
    s_add_u32 s53, s53, 20480
    s_mov_b32 s54, 0xbfb8aa3b
    s_barrier
    v_add_u32 v20, s32, v3
    v_mul_u32_u24 v20, 136, v20
    v_lshl_add_u32 v20, v4, 3, v20
    s_lshl_b32 s52, s30, 6
    v_add_u32 v20, s52, v20
    v_cvt_pk_bf16_f32 v64, v64, v64
    v_lshlrev_b32 v64, 16, v64
    v_cvt_pk_bf16_f32 v96, v96, v96
    v_lshlrev_b32 v96, 16, v96
    v_mul_f32 v60, s54, v96
    v_exp_f32 v60, v60
    s_nop 0
    v_add_f32 v60, 1.0, v60
    v_rcp_f32 v61, v60
    s_nop 0
    v_mul_f32 v96, v96, v61
    v_cvt_pk_bf16_f32 v96, v96, v96
    v_lshlrev_b32 v96, 16, v96
    v_mul_f32 v64, v64, v96
    v_cvt_pk_bf16_f32 v65, v65, v65
    v_lshlrev_b32 v65, 16, v65
    v_cvt_pk_bf16_f32 v97, v97, v97
    v_lshlrev_b32 v97, 16, v97
    v_mul_f32 v60, s54, v97
    v_exp_f32 v60, v60
    s_nop 0
    v_add_f32 v60, 1.0, v60
    v_rcp_f32 v61, v60
    s_nop 0
    v_mul_f32 v97, v97, v61
    v_cvt_pk_bf16_f32 v97, v97, v97
    v_lshlrev_b32 v97, 16, v97
    v_mul_f32 v65, v65, v97
    v_cvt_pk_bf16_f32 v66, v66, v66
    v_lshlrev_b32 v66, 16, v66
    v_cvt_pk_bf16_f32 v98, v98, v98
    v_lshlrev_b32 v98, 16, v98
    v_mul_f32 v60, s54, v98
    v_exp_f32 v60, v60
    s_nop 0
    v_add_f32 v60, 1.0, v60
    v_rcp_f32 v61, v60
    s_nop 0
    v_mul_f32 v98, v98, v61
    v_cvt_pk_bf16_f32 v98, v98, v98
    v_lshlrev_b32 v98, 16, v98
    v_mul_f32 v66, v66, v98
    v_cvt_pk_bf16_f32 v67, v67, v67
    v_lshlrev_b32 v67, 16, v67
    v_cvt_pk_bf16_f32 v99, v99, v99
    v_lshlrev_b32 v99, 16, v99
    v_mul_f32 v60, s54, v99
    v_exp_f32 v60, v60
    s_nop 0
    v_add_f32 v60, 1.0, v60
    v_rcp_f32 v61, v60
    s_nop 0
    v_mul_f32 v99, v99, v61
    v_cvt_pk_bf16_f32 v99, v99, v99
    v_lshlrev_b32 v99, 16, v99
    v_mul_f32 v67, v67, v99
    v_cvt_pk_bf16_f32 v64, v64, v65
    v_cvt_pk_bf16_f32 v65, v66, v67
    ds_write_b64 v20, v[64:65] offset:0
    v_cvt_pk_bf16_f32 v68, v68, v68
    v_lshlrev_b32 v68, 16, v68
    v_cvt_pk_bf16_f32 v100, v100, v100
    v_lshlrev_b32 v100, 16, v100
    v_mul_f32 v60, s54, v100
    v_exp_f32 v60, v60
    s_nop 0
    v_add_f32 v60, 1.0, v60
    v_rcp_f32 v61, v60
    s_nop 0
    v_mul_f32 v100, v100, v61
    v_cvt_pk_bf16_f32 v100, v100, v100
    v_lshlrev_b32 v100, 16, v100
    v_mul_f32 v68, v68, v100
    v_cvt_pk_bf16_f32 v69, v69, v69
    v_lshlrev_b32 v69, 16, v69
    v_cvt_pk_bf16_f32 v101, v101, v101
    v_lshlrev_b32 v101, 16, v101
    v_mul_f32 v60, s54, v101
    v_exp_f32 v60, v60
    s_nop 0
    v_add_f32 v60, 1.0, v60
    v_rcp_f32 v61, v60
    s_nop 0
    v_mul_f32 v101, v101, v61
    v_cvt_pk_bf16_f32 v101, v101, v101
    v_lshlrev_b32 v101, 16, v101
    v_mul_f32 v69, v69, v101
    v_cvt_pk_bf16_f32 v70, v70, v70
    v_lshlrev_b32 v70, 16, v70
    v_cvt_pk_bf16_f32 v102, v102, v102
    v_lshlrev_b32 v102, 16, v102
    v_mul_f32 v60, s54, v102
    v_exp_f32 v60, v60
    s_nop 0
    v_add_f32 v60, 1.0, v60
    v_rcp_f32 v61, v60
    s_nop 0
    v_mul_f32 v102, v102, v61
    v_cvt_pk_bf16_f32 v102, v102, v102
    v_lshlrev_b32 v102, 16, v102
    v_mul_f32 v70, v70, v102
    v_cvt_pk_bf16_f32 v71, v71, v71
    v_lshlrev_b32 v71, 16, v71
    v_cvt_pk_bf16_f32 v103, v103, v103
    v_lshlrev_b32 v103, 16, v103
    v_mul_f32 v60, s54, v103
    v_exp_f32 v60, v60
    s_nop 0
    v_add_f32 v60, 1.0, v60
    v_rcp_f32 v61, v60
    s_nop 0
    v_mul_f32 v103, v103, v61
    v_cvt_pk_bf16_f32 v103, v103, v103
    v_lshlrev_b32 v103, 16, v103
    v_mul_f32 v71, v71, v103
    v_cvt_pk_bf16_f32 v68, v68, v69
    v_cvt_pk_bf16_f32 v69, v70, v71
    ds_write_b64 v20, v[68:69] offset:16
    v_cvt_pk_bf16_f32 v72, v72, v72
    v_lshlrev_b32 v72, 16, v72
    v_cvt_pk_bf16_f32 v104, v104, v104
    v_lshlrev_b32 v104, 16, v104
    v_mul_f32 v60, s54, v104
    v_exp_f32 v60, v60
    s_nop 0
    v_add_f32 v60, 1.0, v60
    v_rcp_f32 v61, v60
    s_nop 0
    v_mul_f32 v104, v104, v61
    v_cvt_pk_bf16_f32 v104, v104, v104
    v_lshlrev_b32 v104, 16, v104
    v_mul_f32 v72, v72, v104
    v_cvt_pk_bf16_f32 v73, v73, v73
    v_lshlrev_b32 v73, 16, v73
    v_cvt_pk_bf16_f32 v105, v105, v105
    v_lshlrev_b32 v105, 16, v105
    v_mul_f32 v60, s54, v105
    v_exp_f32 v60, v60
    s_nop 0
    v_add_f32 v60, 1.0, v60
    v_rcp_f32 v61, v60
    s_nop 0
    v_mul_f32 v105, v105, v61
    v_cvt_pk_bf16_f32 v105, v105, v105
    v_lshlrev_b32 v105, 16, v105
    v_mul_f32 v73, v73, v105
    v_cvt_pk_bf16_f32 v74, v74, v74
    v_lshlrev_b32 v74, 16, v74
    v_cvt_pk_bf16_f32 v106, v106, v106
    v_lshlrev_b32 v106, 16, v106
    v_mul_f32 v60, s54, v106
    v_exp_f32 v60, v60
    s_nop 0
    v_add_f32 v60, 1.0, v60
    v_rcp_f32 v61, v60
    s_nop 0
    v_mul_f32 v106, v106, v61
    v_cvt_pk_bf16_f32 v106, v106, v106
    v_lshlrev_b32 v106, 16, v106
    v_mul_f32 v74, v74, v106
    v_cvt_pk_bf16_f32 v75, v75, v75
    v_lshlrev_b32 v75, 16, v75
    v_cvt_pk_bf16_f32 v107, v107, v107
    v_lshlrev_b32 v107, 16, v107
    v_mul_f32 v60, s54, v107
    v_exp_f32 v60, v60
    s_nop 0
    v_add_f32 v60, 1.0, v60
    v_rcp_f32 v61, v60
    s_nop 0
    v_mul_f32 v107, v107, v61
    v_cvt_pk_bf16_f32 v107, v107, v107
    v_lshlrev_b32 v107, 16, v107
    v_mul_f32 v75, v75, v107
    v_cvt_pk_bf16_f32 v72, v72, v73
    v_cvt_pk_bf16_f32 v73, v74, v75
    ds_write_b64 v20, v[72:73] offset:32
    v_cvt_pk_bf16_f32 v76, v76, v76
    v_lshlrev_b32 v76, 16, v76
    v_cvt_pk_bf16_f32 v108, v108, v108
    v_lshlrev_b32 v108, 16, v108
    v_mul_f32 v60, s54, v108
    v_exp_f32 v60, v60
    s_nop 0
    v_add_f32 v60, 1.0, v60
    v_rcp_f32 v61, v60
    s_nop 0
    v_mul_f32 v108, v108, v61
    v_cvt_pk_bf16_f32 v108, v108, v108
    v_lshlrev_b32 v108, 16, v108
    v_mul_f32 v76, v76, v108
    v_cvt_pk_bf16_f32 v77, v77, v77
    v_lshlrev_b32 v77, 16, v77
    v_cvt_pk_bf16_f32 v109, v109, v109
    v_lshlrev_b32 v109, 16, v109
    v_mul_f32 v60, s54, v109
    v_exp_f32 v60, v60
    s_nop 0
    v_add_f32 v60, 1.0, v60
    v_rcp_f32 v61, v60
    s_nop 0
    v_mul_f32 v109, v109, v61
    v_cvt_pk_bf16_f32 v109, v109, v109
    v_lshlrev_b32 v109, 16, v109
    v_mul_f32 v77, v77, v109
    v_cvt_pk_bf16_f32 v78, v78, v78
    v_lshlrev_b32 v78, 16, v78
    v_cvt_pk_bf16_f32 v110, v110, v110
    v_lshlrev_b32 v110, 16, v110
    v_mul_f32 v60, s54, v110
    v_exp_f32 v60, v60
    s_nop 0
    v_add_f32 v60, 1.0, v60
    v_rcp_f32 v61, v60
    s_nop 0
    v_mul_f32 v110, v110, v61
    v_cvt_pk_bf16_f32 v110, v110, v110
    v_lshlrev_b32 v110, 16, v110
    v_mul_f32 v78, v78, v110
    v_cvt_pk_bf16_f32 v79, v79, v79
    v_lshlrev_b32 v79, 16, v79
    v_cvt_pk_bf16_f32 v111, v111, v111
    v_lshlrev_b32 v111, 16, v111
    v_mul_f32 v60, s54, v111
    v_exp_f32 v60, v60
    s_nop 0
    v_add_f32 v60, 1.0, v60
    v_rcp_f32 v61, v60
    s_nop 0
    v_mul_f32 v111, v111, v61
    v_cvt_pk_bf16_f32 v111, v111, v111
    v_lshlrev_b32 v111, 16, v111
    v_mul_f32 v79, v79, v111
    v_cvt_pk_bf16_f32 v76, v76, v77
    v_cvt_pk_bf16_f32 v77, v78, v79
    ds_write_b64 v20, v[76:77] offset:48
    v_cvt_pk_bf16_f32 v80, v80, v80
    v_lshlrev_b32 v80, 16, v80
    v_cvt_pk_bf16_f32 v112, v112, v112
    v_lshlrev_b32 v112, 16, v112
    v_mul_f32 v60, s54, v112
    v_exp_f32 v60, v60
    s_nop 0
    v_add_f32 v60, 1.0, v60
    v_rcp_f32 v61, v60
    s_nop 0
    v_mul_f32 v112, v112, v61
    v_cvt_pk_bf16_f32 v112, v112, v112
    v_lshlrev_b32 v112, 16, v112
    v_mul_f32 v80, v80, v112
    v_cvt_pk_bf16_f32 v81, v81, v81
    v_lshlrev_b32 v81, 16, v81
    v_cvt_pk_bf16_f32 v113, v113, v113
    v_lshlrev_b32 v113, 16, v113
    v_mul_f32 v60, s54, v113
    v_exp_f32 v60, v60
    s_nop 0
    v_add_f32 v60, 1.0, v60
    v_rcp_f32 v61, v60
    s_nop 0
    v_mul_f32 v113, v113, v61
    v_cvt_pk_bf16_f32 v113, v113, v113
    v_lshlrev_b32 v113, 16, v113
    v_mul_f32 v81, v81, v113
    v_cvt_pk_bf16_f32 v82, v82, v82
    v_lshlrev_b32 v82, 16, v82
    v_cvt_pk_bf16_f32 v114, v114, v114
    v_lshlrev_b32 v114, 16, v114
    v_mul_f32 v60, s54, v114
    v_exp_f32 v60, v60
    s_nop 0
    v_add_f32 v60, 1.0, v60
    v_rcp_f32 v61, v60
    s_nop 0
    v_mul_f32 v114, v114, v61
    v_cvt_pk_bf16_f32 v114, v114, v114
    v_lshlrev_b32 v114, 16, v114
    v_mul_f32 v82, v82, v114
    v_cvt_pk_bf16_f32 v83, v83, v83
    v_lshlrev_b32 v83, 16, v83
    v_cvt_pk_bf16_f32 v115, v115, v115
    v_lshlrev_b32 v115, 16, v115
    v_mul_f32 v60, s54, v115
    v_exp_f32 v60, v60
    s_nop 0
    v_add_f32 v60, 1.0, v60
    v_rcp_f32 v61, v60
    s_nop 0
    v_mul_f32 v115, v115, v61
    v_cvt_pk_bf16_f32 v115, v115, v115
    v_lshlrev_b32 v115, 16, v115
    v_mul_f32 v83, v83, v115
    v_cvt_pk_bf16_f32 v80, v80, v81
    v_cvt_pk_bf16_f32 v81, v82, v83
    ds_write_b64 v20, v[80:81] offset:4352
    v_cvt_pk_bf16_f32 v84, v84, v84
    v_lshlrev_b32 v84, 16, v84
    v_cvt_pk_bf16_f32 v116, v116, v116
    v_lshlrev_b32 v116, 16, v116
    v_mul_f32 v60, s54, v116
    v_exp_f32 v60, v60
    s_nop 0
    v_add_f32 v60, 1.0, v60
    v_rcp_f32 v61, v60
    s_nop 0
    v_mul_f32 v116, v116, v61
    v_cvt_pk_bf16_f32 v116, v116, v116
    v_lshlrev_b32 v116, 16, v116
    v_mul_f32 v84, v84, v116
    v_cvt_pk_bf16_f32 v85, v85, v85
    v_lshlrev_b32 v85, 16, v85
    v_cvt_pk_bf16_f32 v117, v117, v117
    v_lshlrev_b32 v117, 16, v117
    v_mul_f32 v60, s54, v117
    v_exp_f32 v60, v60
    s_nop 0
    v_add_f32 v60, 1.0, v60
    v_rcp_f32 v61, v60
    s_nop 0
    v_mul_f32 v117, v117, v61
    v_cvt_pk_bf16_f32 v117, v117, v117
    v_lshlrev_b32 v117, 16, v117
    v_mul_f32 v85, v85, v117
    v_cvt_pk_bf16_f32 v86, v86, v86
    v_lshlrev_b32 v86, 16, v86
    v_cvt_pk_bf16_f32 v118, v118, v118
    v_lshlrev_b32 v118, 16, v118
    v_mul_f32 v60, s54, v118
    v_exp_f32 v60, v60
    s_nop 0
    v_add_f32 v60, 1.0, v60
    v_rcp_f32 v61, v60
    s_nop 0
    v_mul_f32 v118, v118, v61
    v_cvt_pk_bf16_f32 v118, v118, v118
    v_lshlrev_b32 v118, 16, v118
    v_mul_f32 v86, v86, v118
    v_cvt_pk_bf16_f32 v87, v87, v87
    v_lshlrev_b32 v87, 16, v87
    v_cvt_pk_bf16_f32 v119, v119, v119
    v_lshlrev_b32 v119, 16, v119
    v_mul_f32 v60, s54, v119
    v_exp_f32 v60, v60
    s_nop 0
    v_add_f32 v60, 1.0, v60
    v_rcp_f32 v61, v60
    s_nop 0
    v_mul_f32 v119, v119, v61
    v_cvt_pk_bf16_f32 v119, v119, v119
    v_lshlrev_b32 v119, 16, v119
    v_mul_f32 v87, v87, v119
    v_cvt_pk_bf16_f32 v84, v84, v85
    v_cvt_pk_bf16_f32 v85, v86, v87
    ds_write_b64 v20, v[84:85] offset:4368
    v_cvt_pk_bf16_f32 v88, v88, v88
    v_lshlrev_b32 v88, 16, v88
    v_cvt_pk_bf16_f32 v120, v120, v120
    v_lshlrev_b32 v120, 16, v120
    v_mul_f32 v60, s54, v120
    v_exp_f32 v60, v60
    s_nop 0
    v_add_f32 v60, 1.0, v60
    v_rcp_f32 v61, v60
    s_nop 0
    v_mul_f32 v120, v120, v61
    v_cvt_pk_bf16_f32 v120, v120, v120
    v_lshlrev_b32 v120, 16, v120
    v_mul_f32 v88, v88, v120
    v_cvt_pk_bf16_f32 v89, v89, v89
    v_lshlrev_b32 v89, 16, v89
    v_cvt_pk_bf16_f32 v121, v121, v121
    v_lshlrev_b32 v121, 16, v121
    v_mul_f32 v60, s54, v121
    v_exp_f32 v60, v60
    s_nop 0
    v_add_f32 v60, 1.0, v60
    v_rcp_f32 v61, v60
    s_nop 0
    v_mul_f32 v121, v121, v61
    v_cvt_pk_bf16_f32 v121, v121, v121
    v_lshlrev_b32 v121, 16, v121
    v_mul_f32 v89, v89, v121
    v_cvt_pk_bf16_f32 v90, v90, v90
    v_lshlrev_b32 v90, 16, v90
    v_cvt_pk_bf16_f32 v122, v122, v122
    v_lshlrev_b32 v122, 16, v122
    v_mul_f32 v60, s54, v122
    v_exp_f32 v60, v60
    s_nop 0
    v_add_f32 v60, 1.0, v60
    v_rcp_f32 v61, v60
    s_nop 0
    v_mul_f32 v122, v122, v61
    v_cvt_pk_bf16_f32 v122, v122, v122
    v_lshlrev_b32 v122, 16, v122
    v_mul_f32 v90, v90, v122
    v_cvt_pk_bf16_f32 v91, v91, v91
    v_lshlrev_b32 v91, 16, v91
    v_cvt_pk_bf16_f32 v123, v123, v123
    v_lshlrev_b32 v123, 16, v123
    v_mul_f32 v60, s54, v123
    v_exp_f32 v60, v60
    s_nop 0
    v_add_f32 v60, 1.0, v60
    v_rcp_f32 v61, v60
    s_nop 0
    v_mul_f32 v123, v123, v61
    v_cvt_pk_bf16_f32 v123, v123, v123
    v_lshlrev_b32 v123, 16, v123
    v_mul_f32 v91, v91, v123
    v_cvt_pk_bf16_f32 v88, v88, v89
    v_cvt_pk_bf16_f32 v89, v90, v91
    ds_write_b64 v20, v[88:89] offset:4384
    v_cvt_pk_bf16_f32 v92, v92, v92
    v_lshlrev_b32 v92, 16, v92
    v_cvt_pk_bf16_f32 v124, v124, v124
    v_lshlrev_b32 v124, 16, v124
    v_mul_f32 v60, s54, v124
    v_exp_f32 v60, v60
    s_nop 0
    v_add_f32 v60, 1.0, v60
    v_rcp_f32 v61, v60
    s_nop 0
    v_mul_f32 v124, v124, v61
    v_cvt_pk_bf16_f32 v124, v124, v124
    v_lshlrev_b32 v124, 16, v124
    v_mul_f32 v92, v92, v124
    v_cvt_pk_bf16_f32 v93, v93, v93
    v_lshlrev_b32 v93, 16, v93
    v_cvt_pk_bf16_f32 v125, v125, v125
    v_lshlrev_b32 v125, 16, v125
    v_mul_f32 v60, s54, v125
    v_exp_f32 v60, v60
    s_nop 0
    v_add_f32 v60, 1.0, v60
    v_rcp_f32 v61, v60
    s_nop 0
    v_mul_f32 v125, v125, v61
    v_cvt_pk_bf16_f32 v125, v125, v125
    v_lshlrev_b32 v125, 16, v125
    v_mul_f32 v93, v93, v125
    v_cvt_pk_bf16_f32 v94, v94, v94
    v_lshlrev_b32 v94, 16, v94
    v_cvt_pk_bf16_f32 v126, v126, v126
    v_lshlrev_b32 v126, 16, v126
    v_mul_f32 v60, s54, v126
    v_exp_f32 v60, v60
    s_nop 0
    v_add_f32 v60, 1.0, v60
    v_rcp_f32 v61, v60
    s_nop 0
    v_mul_f32 v126, v126, v61
    v_cvt_pk_bf16_f32 v126, v126, v126
    v_lshlrev_b32 v126, 16, v126
    v_mul_f32 v94, v94, v126
    v_cvt_pk_bf16_f32 v95, v95, v95
    v_lshlrev_b32 v95, 16, v95
    v_cvt_pk_bf16_f32 v127, v127, v127
    v_lshlrev_b32 v127, 16, v127
    v_mul_f32 v60, s54, v127
    v_exp_f32 v60, v60
    s_nop 0
    v_add_f32 v60, 1.0, v60
    v_rcp_f32 v61, v60
    s_nop 0
    v_mul_f32 v127, v127, v61
    v_cvt_pk_bf16_f32 v127, v127, v127
    v_lshlrev_b32 v127, 16, v127
    v_mul_f32 v95, v95, v127
    v_cvt_pk_bf16_f32 v92, v92, v93
    v_cvt_pk_bf16_f32 v93, v94, v95
    ds_write_b64 v20, v[92:93] offset:4400
    s_waitcnt lgkmcnt(0)
    s_barrier
    v_mul_u32_u24 v24, 136, v22
    v_lshl_add_u32 v24, v21, 3, v24
    ds_read_b64 v[64:65], v24 offset:0
    ds_read_b64 v[66:67], v24 offset:2176
    ds_read_b64 v[68:69], v24 offset:4352
    ds_read_b64 v[70:71], v24 offset:6528
    ds_read_b64 v[72:73], v24 offset:8704
    ds_read_b64 v[74:75], v24 offset:10880
    ds_read_b64 v[76:77], v24 offset:13056
    ds_read_b64 v[78:79], v24 offset:15232
    s_waitcnt vmcnt(0) lgkmcnt(0)
    s_mov_b32 s53, 0
    v_lshlrev_b32 v60, 16, v32
    v_and_b32 v61, 0xffff0000, v32
    v_lshlrev_b32 v62, 16, v64
    v_and_b32 v63, 0xffff0000, v64
    v_add_f32 v60, v60, v62
    v_add_f32 v61, v61, v63
    v_cvt_pk_bf16_f32 v64, v60, v61
    v_lshlrev_b32 v60, 16, v33
    v_and_b32 v61, 0xffff0000, v33
    v_lshlrev_b32 v62, 16, v65
    v_and_b32 v63, 0xffff0000, v65
    v_add_f32 v60, v60, v62
    v_add_f32 v61, v61, v63
    v_cvt_pk_bf16_f32 v65, v60, v61
    buffer_store_dwordx2 v[64:65], v23, s[40:43], s53 offen
    s_add_u32 s53, s53, 20480
    v_lshlrev_b32 v60, 16, v34
    v_and_b32 v61, 0xffff0000, v34
    v_lshlrev_b32 v62, 16, v66
    v_and_b32 v63, 0xffff0000, v66
    v_add_f32 v60, v60, v62
    v_add_f32 v61, v61, v63
    v_cvt_pk_bf16_f32 v66, v60, v61
    v_lshlrev_b32 v60, 16, v35
    v_and_b32 v61, 0xffff0000, v35
    v_lshlrev_b32 v62, 16, v67
    v_and_b32 v63, 0xffff0000, v67
    v_add_f32 v60, v60, v62
    v_add_f32 v61, v61, v63
    v_cvt_pk_bf16_f32 v67, v60, v61
    buffer_store_dwordx2 v[66:67], v23, s[40:43], s53 offen
    s_add_u32 s53, s53, 20480
    v_lshlrev_b32 v60, 16, v36
    v_and_b32 v61, 0xffff0000, v36
    v_lshlrev_b32 v62, 16, v68
    v_and_b32 v63, 0xffff0000, v68
    v_add_f32 v60, v60, v62
    v_add_f32 v61, v61, v63
    v_cvt_pk_bf16_f32 v68, v60, v61
    v_lshlrev_b32 v60, 16, v37
    v_and_b32 v61, 0xffff0000, v37
    v_lshlrev_b32 v62, 16, v69
    v_and_b32 v63, 0xffff0000, v69
    v_add_f32 v60, v60, v62
    v_add_f32 v61, v61, v63
    v_cvt_pk_bf16_f32 v69, v60, v61
    buffer_store_dwordx2 v[68:69], v23, s[40:43], s53 offen
    s_add_u32 s53, s53, 20480
    v_lshlrev_b32 v60, 16, v38
    v_and_b32 v61, 0xffff0000, v38
    v_lshlrev_b32 v62, 16, v70
    v_and_b32 v63, 0xffff0000, v70
    v_add_f32 v60, v60, v62
    v_add_f32 v61, v61, v63
    v_cvt_pk_bf16_f32 v70, v60, v61
    v_lshlrev_b32 v60, 16, v39
    v_and_b32 v61, 0xffff0000, v39
    v_lshlrev_b32 v62, 16, v71
    v_and_b32 v63, 0xffff0000, v71
    v_add_f32 v60, v60, v62
    v_add_f32 v61, v61, v63
    v_cvt_pk_bf16_f32 v71, v60, v61
    buffer_store_dwordx2 v[70:71], v23, s[40:43], s53 offen
    s_add_u32 s53, s53, 20480
    v_lshlrev_b32 v60, 16, v40
    v_and_b32 v61, 0xffff0000, v40
    v_lshlrev_b32 v62, 16, v72
    v_and_b32 v63, 0xffff0000, v72
    v_add_f32 v60, v60, v62
    v_add_f32 v61, v61, v63
    v_cvt_pk_bf16_f32 v72, v60, v61
    v_lshlrev_b32 v60, 16, v41
    v_and_b32 v61, 0xffff0000, v41
    v_lshlrev_b32 v62, 16, v73
    v_and_b32 v63, 0xffff0000, v73
    v_add_f32 v60, v60, v62
    v_add_f32 v61, v61, v63
    v_cvt_pk_bf16_f32 v73, v60, v61
    buffer_store_dwordx2 v[72:73], v23, s[40:43], s53 offen
    s_add_u32 s53, s53, 20480
    v_lshlrev_b32 v60, 16, v42
    v_and_b32 v61, 0xffff0000, v42
    v_lshlrev_b32 v62, 16, v74
    v_and_b32 v63, 0xffff0000, v74
    v_add_f32 v60, v60, v62
    v_add_f32 v61, v61, v63
    v_cvt_pk_bf16_f32 v74, v60, v61
    v_lshlrev_b32 v60, 16, v43
    v_and_b32 v61, 0xffff0000, v43
    v_lshlrev_b32 v62, 16, v75
    v_and_b32 v63, 0xffff0000, v75
    v_add_f32 v60, v60, v62
    v_add_f32 v61, v61, v63
    v_cvt_pk_bf16_f32 v75, v60, v61
    buffer_store_dwordx2 v[74:75], v23, s[40:43], s53 offen
    s_add_u32 s53, s53, 20480
    v_lshlrev_b32 v60, 16, v44
    v_and_b32 v61, 0xffff0000, v44
    v_lshlrev_b32 v62, 16, v76
    v_and_b32 v63, 0xffff0000, v76
    v_add_f32 v60, v60, v62
    v_add_f32 v61, v61, v63
    v_cvt_pk_bf16_f32 v76, v60, v61
    v_lshlrev_b32 v60, 16, v45
    v_and_b32 v61, 0xffff0000, v45
    v_lshlrev_b32 v62, 16, v77
    v_and_b32 v63, 0xffff0000, v77
    v_add_f32 v60, v60, v62
    v_add_f32 v61, v61, v63
    v_cvt_pk_bf16_f32 v77, v60, v61
    buffer_store_dwordx2 v[76:77], v23, s[40:43], s53 offen
    s_add_u32 s53, s53, 20480
    v_lshlrev_b32 v60, 16, v46
    v_and_b32 v61, 0xffff0000, v46
    v_lshlrev_b32 v62, 16, v78
    v_and_b32 v63, 0xffff0000, v78
    v_add_f32 v60, v60, v62
    v_add_f32 v61, v61, v63
    v_cvt_pk_bf16_f32 v78, v60, v61
    v_lshlrev_b32 v60, 16, v47
    v_and_b32 v61, 0xffff0000, v47
    v_lshlrev_b32 v62, 16, v79
    v_and_b32 v63, 0xffff0000, v79
    v_add_f32 v60, v60, v62
    v_add_f32 v61, v61, v63
    v_cvt_pk_bf16_f32 v79, v60, v61
    buffer_store_dwordx2 v[78:79], v23, s[40:43], s53 offen
    s_add_u32 s53, s53, 20480
L_g2_end_37:
    s_endpgm
.section .rodata,"a"
.p2align 6
.amdhsa_kernel ln_kernel
  .amdhsa_next_free_vgpr 64
  .amdhsa_next_free_sgpr 96
  .amdhsa_accum_offset 64
  .amdhsa_group_segment_fixed_size 0
  .amdhsa_kernarg_size 72
  .amdhsa_user_sgpr_count 2
  .amdhsa_user_sgpr_kernarg_segment_ptr 1
  .amdhsa_system_sgpr_workgroup_id_x 1
.end_amdhsa_kernel
.p2align 6
.amdhsa_kernel gemm1_kernel
  .amdhsa_next_free_vgpr 128
  .amdhsa_next_free_sgpr 96
  .amdhsa_accum_offset 128
  .amdhsa_group_segment_fixed_size 0
  .amdhsa_kernarg_size 72
  .amdhsa_user_sgpr_count 2
  .amdhsa_user_sgpr_kernarg_segment_ptr 1
  .amdhsa_system_sgpr_workgroup_id_x 1
.end_amdhsa_kernel
.p2align 6
.amdhsa_kernel attn_kernel
  .amdhsa_next_free_vgpr 256
  .amdhsa_next_free_sgpr 96
  .amdhsa_accum_offset 256
  .amdhsa_group_segment_fixed_size 0
  .amdhsa_kernarg_size 72
  .amdhsa_user_sgpr_count 2
  .amdhsa_user_sgpr_kernarg_segment_ptr 1
  .amdhsa_system_sgpr_workgroup_id_x 1
.end_amdhsa_kernel
.p2align 6
.amdhsa_kernel gemm2_kernel
  .amdhsa_next_free_vgpr 152
  .amdhsa_next_free_sgpr 96
  .amdhsa_accum_offset 152
  .amdhsa_group_segment_fixed_size 0
  .amdhsa_kernarg_size 72
  .amdhsa_user_sgpr_count 2
  .amdhsa_user_sgpr_kernarg_segment_ptr 1
  .amdhsa_system_sgpr_workgroup_id_x 1
.end_amdhsa_kernel
```
